```python
import torch

def _softmax(x, axis=-1):
    return torch.softmax(x, dim=axis)
def _gelu(x):
    return torch.nn.functional.gelu(x, approximate="tanh")
def _silu(x):
    return torch.nn.functional.silu(x)
def _sigmoid(x):
    return torch.sigmoid(x)
def _layernorm(x, axis=-1, eps=1e-5):
    m = x.mean(dim=axis, keepdim=True)
    v = x.var(dim=axis, keepdim=True, unbiased=False)
    return (x - m) / torch.sqrt(v + eps)
def _scatter_add(tgt, idx, src, axis=0):
    return tgt.clone().index_add_(axis, idx, src)
def _segment_sum(src, seg, n):
    out = torch.zeros((n,) + src.shape[1:], dtype=src.dtype)
    return out.index_add_(0, seg, src)
def _pad(x, pw):
    flat = tuple(v for pair in reversed(pw) for v in pair)
    return torch.nn.functional.pad(x, flat)

kernel_name = 'standalone__sliding_block_cached__decode'

def setup_inputs():

    _w = (lambda a: (lambda t: t.to(torch.bfloat16) if t.is_floating_point() else t)(torch.as_tensor(a)))
    B, Sq, D = 8, 1, 448
    Hq, Hkv, Sk, Dh = 16, 8, 8192, 256
    assert Hq % Hkv == 0, (Hq, Hkv)
    return {
        "x": _w((lambda *s: torch.randn(*s, dtype=torch.bfloat16) * 0.8)(B, Sq, D)),
        "k_cache": _w((lambda *s: torch.randn(*s, dtype=torch.bfloat16) * 0.8)(B, Hkv, Sk, Dh)),
        "v_cache": _w((lambda *s: torch.randn(*s, dtype=torch.bfloat16) * 0.05)(B, Hkv, Sk, Dh)),
        "wq": _w((lambda *s: torch.randn(*s, dtype=torch.bfloat16) * 0.8)(D, Hq * Dh) * (D ** -0.5)),
        "wo": _w((lambda *s: torch.randn(*s, dtype=torch.bfloat16) * 0.05)(Hq * Dh, D) * ((Hq * Dh) ** -0.5)),
    }

def reference(x, k_cache, v_cache, wq, wo):
    B, Sq, D = x.shape
    Hq, Dh = 16, 256
    Hkv, Sk = k_cache.shape[1], k_cache.shape[2]
    W = min(4096, max(256, Sk // 4))
    rep = Hq // Hkv
    q = (lambda x, *d: x.permute(*d))((x @ wq).reshape(B, Sq, Hq, Dh), 0, 2, 1, 3)
    k = (lambda x, n, axis: torch.repeat_interleave(x, n, dim=axis))(k_cache[:, :, Sk - W:, :], rep, axis=1)
    v = (lambda x, n, axis: torch.repeat_interleave(x, n, dim=axis))(v_cache[:, :, Sk - W:, :], rep, axis=1)
    scores = torch.einsum("bhqd,bhkd->bhqk", q, k) * (Dh ** -0.5)
    p = _softmax(scores, axis=-1)
    o = torch.einsum("bhqk,bhkd->bhqd", p, v)
    return (lambda x, *d: x.permute(*d))(o, 0, 2, 1, 3).reshape(B, Sq, Hq * Dh) @ wo
```

```asm
; @launch grid=(256,1,1) block=(256,1,1) lds=155904
.amdgcn_target "amdgcn-amd-amdhsa--gfx950"
.text
.globl standalone__sliding_block_cached__decode_kernel
.p2align 12
.fill 832, 4, 0xbf810000
.type standalone__sliding_block_cached__decode_kernel,@function
standalone__sliding_block_cached__decode_kernel:
    s_load_dwordx16 s[4:19], s[0:1], 0
    s_cmp_ge_u32 s2, 256
    s_cbranch_scc1 L_end
    v_lshrrev_b32 v1, 6, v0
    v_and_b32 v0, 63, v0
    s_and_b32 s55, s2, 7
    s_lshr_b32 s58, s2, 3
    s_and_b32 s52, s58, 3
    s_lshr_b32 s54, s58, 2
    s_lshl_b32 s53, s54, 3
    s_add_u32 s53, s53, s55
    v_readfirstlane_b32 s48, v1
    v_and_b32 v14, 7, v0
    v_lshrrev_b32 v15, 3, v0
    v_lshlrev_b32 v1, 9, v14
    v_lshl_add_u32 v1, v15, 4, v1
    v_bfe_u32 v1, v0, 2, 2
    v_lshlrev_b32 v1, 9, v1
    v_lshrrev_b32 v5, 4, v0
    v_lshl_add_u32 v1, v5, 6, v1
    v_and_b32 v5, 3, v0
    v_lshl_add_u32 v1, v5, 4, v1
    s_lshl_b32 s50, s53, 22
    s_add_u32 s50, s50, 3145728
    s_lshl_b32 s58, s48, 12
    s_add_u32 s50, s50, s58
    s_lshl_b32 s58, s52, 7
    s_add_u32 s51, s50, s58
    s_lshl_b32 s58, s52, 18
    s_add_u32 s50, s50, s58
    s_mov_b32 s23, 0x20000
    s_mov_b32 s22, 0x10000000
    s_mov_b32 s35, 0x20000
    s_mov_b32 s39, 0x20000
    s_mov_b32 s34, 3670016
    s_mov_b32 s38, 7168
    v_lshlrev_b32 v12, 13, v15
    v_lshl_add_u32 v12, v14, 4, v12
    v_mul_u32_u24 v13, 896, v14
    v_lshrrev_b32 v10, 4, v0
    v_lshl_add_u32 v13, v10, 4, v13
    s_mul_i32 s69, s52, 288
    s_cmp_eq_u32 s52, 3
    s_cselect_b32 s69, 0x10000, s69
    s_lshl_b32 s68, s69, 12
    s_mul_i32 s58, s48, 327680
    s_add_u32 s68, s68, s58
    s_lshl_b32 s58, s55, 3
    s_add_u32 s58, s58, s54
    s_xor_b32 s58, s58, 3
    s_lshl_b32 s58, s58, 7
    s_add_u32 s68, s68, s58
    s_lshl_b32 s99, s48, 2
    s_sub_u32 s99, s99, s52
    s_mul_i32 s57, s48, 5120
    s_add_u32 s57, s57, 114688
    s_mul_i32 s100, s52, 16384
    s_and_b32 s100, s100, 262143
    s_mov_b32 s98, s50
    s_add_u32 s50, s98, s100
    s_waitcnt lgkmcnt(0)
    s_mov_b32 s20, s6
    s_mov_b32 s21, s7
    buffer_load_dwordx4 a[0:3], v1, s[20:23], s50 offen offset:0 nt
    s_load_dword s49, s[18:19], 0
    s_mov_b32 s32, s10
    s_mov_b32 s33, s11
    s_mov_b32 s36, s4
    s_mov_b32 s37, s5
    buffer_load_dwordx4 a[4:7], v1, s[20:23], s50 offen offset:256 nt
    buffer_load_dwordx4 a[8:11], v1, s[20:23], s50 offen offset:2048 nt
    s_mov_b32 m0, s57
    s_nop 0
    buffer_load_dwordx4 v12, s[32:35], s68 offen nt lds
    buffer_load_dwordx4 v[144:147], v13, s[36:39], s69 offen offset:0
    s_add_u32 s68, s68, 65536
    s_add_u32 s57, s57, 1024
    buffer_load_dwordx4 a[12:15], v1, s[20:23], s50 offen offset:2304 nt
    s_add_u32 s100, s100, 16384
    s_and_b32 s100, s100, 262143
    s_add_u32 s50, s98, s100
    buffer_load_dwordx4 a[16:19], v1, s[20:23], s50 offen offset:0 nt
    buffer_load_dwordx4 a[20:23], v1, s[20:23], s50 offen offset:256 nt
    v_lshlrev_b32 v2, 9, v15
    v_lshl_add_u32 v2, v14, 4, v2
    v_lshlrev_b32 v3, 4, v0
    v_lshlrev_b32 v4, 3, v0
    s_mov_b32 s27, 0x20000
    s_mov_b32 s31, 0x20000
    s_mov_b32 s43, 0x20000
    s_mov_b32 s47, 0x20000
    s_mov_b32 s26, 0x10000000
    s_mov_b32 s30, 0x40000000
    s_mov_b32 s42, 3670016
    s_mov_b32 s46, 7168
    s_mov_b32 s24, s8
    s_mov_b32 s25, s9
    s_mov_b32 s28, s18
    s_mov_b32 s29, s19
    s_mov_b32 s40, s12
    s_mov_b32 s41, s13
    s_mov_b32 s44, s14
    s_mov_b32 s45, s15
    s_lshl_b32 s56, s55, 1
    s_lshr_b32 s58, s48, 1
    s_add_u32 s56, s56, s58
    s_lshl_b32 s56, s56, 2
    s_add_u32 s56, s56, s52
    s_mul_i32 s56, s56, 57344
    s_and_b32 s58, s48, 1
    s_mul_i32 s58, s58, 28672
    s_add_u32 s56, s56, s58
    s_mul_i32 s3, s48, 28672
    v_and_b32 v5, 1, v0
    v_mov_b32 v6, 0xffff
    v_lshlrev_b32 v7, 4, v5
    v_lshlrev_b32 v11, v7, v6
    v_lshrrev_b32 v5, 1, v14
    v_cmp_eq_u32 vcc, 0, v5
    s_nop 1
    v_cndmask_b32 v6, 0, v11, vcc
    v_cmp_eq_u32 vcc, 1, v5
    s_nop 1
    v_cndmask_b32 v7, 0, v11, vcc
    v_cmp_eq_u32 vcc, 2, v5
    s_nop 1
    v_cndmask_b32 v8, 0, v11, vcc
    v_cmp_eq_u32 vcc, 3, v5
    s_nop 1
    v_cndmask_b32 v9, 0, v11, vcc
    s_mul_i32 s58, s48, 4352
    s_add_u32 s58, s58, 135168
    v_and_b32 v5, 1, v0
    v_lshlrev_b32 v5, 2, v5
    v_and_or_b32 v5, v0, 2, v5
    v_lshrrev_b32 v11, 5, v0
    v_or_b32 v5, v5, v11
    v_mul_u32_u24 v11, 544, v5
    v_and_b32 v5, 12, v0
    v_lshl_add_u32 v11, v5, 1, v11
    v_and_b32 v5, 1, v10
    v_lshl_add_u32 v11, v5, 2, v11
    v_add_u32 v136, s58, v11
    v_bfe_u32 v5, v0, 3, 1
    v_lshl_add_u32 v5, v5, 2, v10
    v_mul_u32_u24 v11, 544, v5
    v_add_u32 v137, s58, v11
    v_bfe_u32 v5, v0, 2, 2
    v_lshl_add_u32 v5, v10, 3, v5
    v_mul_u32_u24 v5, 896, v5
    v_and_b32 v11, 3, v0
    v_lshl_add_u32 v5, v11, 3, v5
    s_mul_i32 s58, s48, 224
    v_add_u32 v138, s58, v5
    v_add_u32 v139, 57344, v138
    v_lshrrev_b32 v5, 5, v0
    v_mul_u32_u24 v5, 272, v5
    v_and_b32 v11, 6, v0
    v_lshl_add_u32 v5, v11, 5, v5
    v_and_b32 v11, 1, v0
    v_lshl_add_u32 v5, v11, 3, v5
    v_and_b32 v11, 1, v10
    v_lshl_add_u32 v5, v11, 2, v5
    v_and_b32 v11, 8, v0
    v_mul_u32_u24 v141, 148, v11
    s_lshl_b32 s58, s48, 4
    s_add_u32 s58, s58, 152832
    v_add3_u32 v140, s58, v5, v141
    v_mul_u32_u24 v5, 72, v11
    v_lshl_add_u32 v5, v10, 6, v5
    v_and_b32 v11, 3, v0
    v_lshl_add_u32 v5, v11, 4, v5
    v_add_u32 v141, 152832, v5
    v_and_b32 v11, 1, v0
    v_lshlrev_b32 v11, 7, v11
    s_lshl_b32 s58, s48, 5
    s_add_u32 s58, s58, 152576
    v_lshl_add_u32 v5, v10, 3, v11
    v_add_u32 v142, s58, v5
    v_and_b32 v5, 14, v0
    v_lshl_add_u32 v5, v5, 3, v11
    v_add_u32 v143, 152576, v5
    s_mov_b32 s67, 0x3db8aa3b
    v_bfe_u32 v5, v0, 2, 2
    v_lshl_add_u32 v5, v10, 3, v5
    v_lshlrev_b32 v5, 7, v5
    v_and_b32 v11, 3, v0
    v_lshl_add_u32 v5, v11, 3, v5
    s_lshl_b32 s58, s48, 5
    s_add_u32 s58, s58, 114688
    v_add_u32 v108, s58, v5
    v_lshlrev_b32 v111, 13, v14
    v_lshl_add_u32 v111, v10, 4, v111
    s_lshl_b32 s58, s48, 8
    s_add_u32 s58, s58, 154880
    v_and_b32 v5, 31, v0
    v_lshl_add_u32 v112, v5, 3, s58
    v_lshrrev_b32 v5, 5, v0
    v_lshl_add_u32 v112, v5, 2, v112
    v_and_b32 v5, 1, v0
    v_lshlrev_b32 v5, 9, v5
    v_lshl_add_u32 v5, v10, 6, v5
    v_and_b32 v11, 12, v0
    v_lshl_add_u32 v5, v11, 2, v5
    v_add_u32 v113, 154880, v5
    s_lshl_b32 s60, s55, 16
    s_add_u32 s60, s60, 4194304
    s_xor_b32 s66, s54, 3
    s_lshr_b32 s58, s66, 1
    s_lshl_b32 s58, s58, 2
    s_add_u32 s58, s58, s52
    s_lshl_b32 s58, s58, 1
    s_and_b32 s66, s66, 1
    s_add_u32 s58, s58, s66
    s_lshl_b32 s58, s58, 2
    s_add_u32 s58, s58, s48
    s_lshl_b32 s58, s58, 6
    s_add_u32 s59, s60, s58
    s_lshl_b32 s66, s54, 13
    s_add_u32 s60, s60, s66
    s_lshl_b32 s58, s48, 11
    s_add_u32 s60, s60, s58
    s_lshl_b32 s61, s53, 2
    s_add_u32 s61, s61, s48
    s_lshl_b32 s61, s61, 11
    s_add_u32 s61, s61, 1048576
    s_lshl_b32 s62, s52, 9
    s_add_u32 s62, s62, s61
    s_lshl_b32 s63, s55, 2
    s_add_u32 s63, s63, s52
    s_lshl_b32 s58, s54, 2
    s_add_u32 s65, s58, s48
    s_mul_i32 s65, s65, 2048
    s_add_u32 s65, s65, 1572864
    s_add_u32 s58, s58, 3
    s_cmp_eq_u32 s58, s63
    s_cselect_b32 s64, s65, 0x7f000000
    v_mov_b64 v[40:41], 0
    v_mov_b64 v[42:43], 0
    s_add_u32 s96, s58, s48
    s_lshl_b32 s96, s96, 7
    s_add_u32 s96, s96, 917504
    s_cmp_eq_u32 s58, s63
    s_cselect_b32 s97, s96, 0x7f000000
    v_and_b32 v45, 60, v0
    v_lshl_add_u32 v45, v45, 4, v3
    v_lshl_add_u32 v46, v15, 6, v4
    s_mov_b32 s12, 0x07060501
    s_mov_b32 s13, 0x07060100
    s_mov_b32 s14, 0x07060302
    s_mov_b32 s15, 0x0706000c
    s_mov_b32 s16, 0x05040100
    v_mov_b32 v116, -1
    v_mov_b32 v117, -1
    s_waitcnt lgkmcnt(0)
    s_mul_i32 s49, s49, 0x0019660D
    s_add_u32 s49, s49, 0x3C6EF35F
    v_mov_b32 v114, s49
    s_xor_b32 s17, s49, 0x00020002
    s_getreg_b32 s10, hwreg(HW_REG_XCC_ID, 0, 4)
    s_lshl_b32 s10, s10, 1
    s_add_u32 s10, s10, s49
    s_lshl_b32 s11, s55, 7
    s_add_u32 s11, s11, 4096
    s_lshr_b32 s58, s2, 3
    s_lshl_b32 s58, s58, 2
    s_add_u32 s58, s58, s11
    s_cmp_eq_u32 s48, 0
    s_cselect_b32 s58, s58, 0x7f000000
    v_mov_b32 v110, s10
    v_and_b32 v109, 31, v0
    v_lshlrev_b32 v109, 2, v109
    s_mov_b64 exec, 1
    buffer_store_dword v110, off, s[28:31], s58
    s_mov_b64 exec, -1
    s_waitcnt vmcnt(7)
    buffer_load_dwordx4 a[24:27], v1, s[20:23], s50 offen offset:2048 nt
    s_waitcnt vmcnt(7)
    buffer_load_dwordx4 a[28:31], v1, s[20:23], s50 offen offset:2304 nt
    s_add_u32 s100, s100, 16384
    s_and_b32 s100, s100, 262143
    s_add_u32 s50, s98, s100
    s_mov_b32 m0, s57
    s_nop 0
    buffer_load_dwordx4 v12, s[32:35], s68 offen nt lds
    buffer_load_dwordx4 v[148:151], v13, s[36:39], s69 offen offset:64
    s_add_u32 s68, s68, 65536
    s_add_u32 s57, s57, 1024
    buffer_store_dwordx2 v[116:117], v4, s[28:31], s62 offen
    buffer_store_dwordx4 v[40:43], v45, s[28:31], s64 offen sc1
    s_waitcnt vmcnt(9)
    buffer_load_dwordx4 a[32:35], v1, s[20:23], s50 offen offset:0 nt
    s_mov_b32 m0, s3
    s_nop 0
    buffer_load_dwordx4 v3, s[40:43], s56 offen offset:0 nt lds
    s_waitcnt vmcnt(10)
    buffer_load_dwordx4 a[36:39], v1, s[20:23], s50 offen offset:256 nt
    s_waitcnt vmcnt(10)
    buffer_load_dwordx4 a[40:43], v1, s[20:23], s50 offen offset:2048 nt
    buffer_load_dwordx4 v3, s[40:43], s56 offen offset:1024 nt lds
    s_waitcnt vmcnt(10)
    buffer_load_dwordx4 a[44:47], v1, s[20:23], s50 offen offset:2304 nt
    s_add_u32 s100, s100, 16384
    s_and_b32 s100, s100, 262143
    s_add_u32 s50, s98, s100
    s_waitcnt vmcnt(10)
    buffer_load_dwordx4 a[48:51], v1, s[20:23], s50 offen offset:0 nt
    s_mov_b32 m0, s57
    s_nop 0
    buffer_load_dwordx4 v12, s[32:35], s68 offen nt lds
    buffer_load_dwordx4 v[152:155], v13, s[36:39], s69 offen offset:128
    s_add_u32 s68, s68, 65536
    s_add_u32 s57, s57, 1024
    s_mov_b32 m0, s3
    s_nop 0
    buffer_load_dwordx4 v3, s[40:43], s56 offen offset:2048 nt lds
    s_waitcnt vmcnt(9)
    buffer_load_dwordx4 a[52:55], v1, s[20:23], s50 offen offset:256 nt
    s_waitcnt vmcnt(8)
    buffer_load_dwordx4 a[56:59], v1, s[20:23], s50 offen offset:2048 nt
    buffer_load_dwordx4 v3, s[40:43], s56 offen offset:3072 nt lds
    s_waitcnt vmcnt(9)
    buffer_load_dwordx4 a[60:63], v1, s[20:23], s50 offen offset:2304 nt
    s_add_u32 s100, s100, 16384
    s_and_b32 s100, s100, 262143
    s_add_u32 s50, s98, s100
    s_waitcnt vmcnt(8)
    buffer_load_dwordx4 a[64:67], v1, s[20:23], s50 offen offset:0 nt
    s_add_u32 s56, s56, 4096
    s_add_u32 s3, s3, 4096
    s_mov_b32 m0, s3
    s_nop 0
    buffer_load_dwordx4 v3, s[40:43], s56 offen offset:0 nt lds
    buffer_load_dword v115, v109, s[28:31], s11 offen sc1 nt
    s_waitcnt vmcnt(10)
    buffer_load_dwordx4 a[68:71], v1, s[20:23], s50 offen offset:256 nt
    s_mov_b32 m0, s57
    s_cmp_ge_i32 s99, 11
    s_cselect_b32 s68, 0x10000000, s68
    buffer_load_dwordx4 v12, s[32:35], s68 offen nt lds
    buffer_load_dwordx4 v[156:159], v13, s[36:39], s69 offen offset:192
    s_add_u32 s68, s68, 65536
    s_add_u32 s57, s57, 1024
    s_waitcnt vmcnt(9)
    buffer_load_dwordx4 a[72:75], v1, s[20:23], s50 offen offset:2048 nt
    s_mov_b32 m0, s3
    s_nop 0
    buffer_load_dwordx4 v3, s[40:43], s56 offen offset:1024 nt lds
    s_waitcnt vmcnt(10)
    buffer_load_dwordx4 a[76:79], v1, s[20:23], s50 offen offset:2304 nt
    s_add_u32 s100, s100, 16384
    s_and_b32 s100, s100, 262143
    s_add_u32 s50, s98, s100
    s_waitcnt vmcnt(9)
    buffer_load_dwordx4 a[80:83], v1, s[20:23], s50 offen offset:0 nt
    buffer_load_dwordx4 v3, s[40:43], s56 offen offset:2048 nt lds
    s_waitcnt vmcnt(10)
    buffer_load_dwordx4 a[84:87], v1, s[20:23], s50 offen offset:256 nt
    s_waitcnt vmcnt(8)
    buffer_load_dwordx4 a[88:91], v1, s[20:23], s50 offen offset:2048 nt
    s_mov_b32 m0, s57
    s_nop 0
    buffer_load_dwordx4 v12, s[32:35], s68 offen nt lds
    buffer_load_dwordx4 v[160:163], v13, s[36:39], s69 offen offset:256
    s_mov_b32 m0, s3
    s_nop 0
    buffer_load_dwordx4 v3, s[40:43], s56 offen offset:3072 nt lds
    s_waitcnt vmcnt(9)
    buffer_load_dwordx4 a[92:95], v1, s[20:23], s50 offen offset:2304 nt
    s_add_u32 s100, s100, 16384
    s_and_b32 s100, s100, 262143
    s_add_u32 s50, s98, s100
    s_waitcnt vmcnt(8)
    buffer_load_dwordx4 a[96:99], v1, s[20:23], s50 offen offset:0 nt
    s_add_u32 s56, s56, 4096
    s_add_u32 s3, s3, 4096
    s_mov_b32 m0, s3
    s_nop 0
    buffer_load_dwordx4 v3, s[40:43], s56 offen offset:0 nt lds
    s_waitcnt vmcnt(9)
    buffer_load_dwordx4 a[100:103], v1, s[20:23], s50 offen offset:256 nt
    s_waitcnt vmcnt(8)
    buffer_load_dwordx4 a[104:107], v1, s[20:23], s50 offen offset:2048 nt
    buffer_load_dwordx4 v3, s[40:43], s56 offen offset:1024 nt lds
    s_waitcnt vmcnt(9)
    buffer_load_dwordx4 a[108:111], v1, s[20:23], s50 offen offset:2304 nt
    s_add_u32 s100, s100, 16384
    s_and_b32 s100, s100, 262143
    s_add_u32 s50, s98, s100
    s_waitcnt vmcnt(8)
    s_barrier
    ds_read_b64_tr_b16 v[164:165], v108 offset:0
    ds_read_b64_tr_b16 v[166:167], v108 offset:512
    ds_read_b64_tr_b16 v[168:169], v108 offset:4096
    ds_read_b64_tr_b16 v[170:171], v108 offset:4608
    ds_read_b64_tr_b16 v[172:173], v108 offset:8192
    ds_read_b64_tr_b16 v[174:175], v108 offset:8704
    ds_read_b64_tr_b16 v[176:177], v108 offset:12288
    ds_read_b64_tr_b16 v[178:179], v108 offset:12800
    ds_read_b64_tr_b16 v[180:181], v108 offset:16384
    ds_read_b64_tr_b16 v[182:183], v108 offset:16896
    s_waitcnt vmcnt(6)
    buffer_load_dwordx4 a[112:115], v1, s[20:23], s50 offen offset:0 nt
    buffer_load_dwordx4 v3, s[40:43], s56 offen offset:2048 nt lds
    s_waitcnt lgkmcnt(0)
    v_mfma_f32_16x16x32_bf16 v[64:67], v[164:167], v[144:147], 0
    v_mfma_f32_16x16x32_bf16 v[64:67], v[168:171], v[148:151], v[64:67]
    v_mfma_f32_16x16x32_bf16 v[64:67], v[172:175], v[152:155], v[64:67]
    v_mfma_f32_16x16x32_bf16 v[64:67], v[176:179], v[156:159], v[64:67]
    v_mfma_f32_16x16x32_bf16 v[64:67], v[180:183], v[160:163], v[64:67]
    s_waitcnt vmcnt(7)
    buffer_load_dwordx4 a[116:119], v1, s[20:23], s50 offen offset:256 nt
    s_nop 7
    v_perm_b32 v80, v64, v65, s12
    v_perm_b32 v81, v65, v114, s13
    v_perm_b32 v82, v66, v67, s12
    v_perm_b32 v83, v67, v114, s14
    s_mov_b64 exec, 1
    buffer_store_dword v114, off, s[28:31], s97 offset:0 sc1
    s_mov_b64 exec, -1
    v_cmp_ne_u32 vcc, s10, v115
    s_cbranch_vccz L_q_fast
    buffer_store_dwordx2 v[116:117], v4, s[28:31], s62 offen sc1 nt
    s_waitcnt vmcnt(0)
    s_mov_b32 exec_lo, 0xff00ff
    s_mov_b32 exec_hi, 0xff00ff
    buffer_store_dwordx4 v[80:83], v111, s[28:31], s59 offen sc1 nt
    s_branch L_q_pub
L_q_fast:
    s_mov_b32 exec_lo, 0xff00ff
    s_mov_b32 exec_hi, 0xff00ff
    buffer_store_dwordx4 v[80:83], v111, s[28:31], s59 offen
L_q_pub:
    s_mov_b64 exec, -1
    v_mov_b32 v16, 0
    v_mov_b32 v17, 0
    v_mov_b32 v18, 0
    v_mov_b32 v19, 0
    v_mov_b32 v20, 0
    v_mov_b32 v21, 0
    v_mov_b32 v22, 0
    v_mov_b32 v23, 0
    v_mov_b32 v24, 0
    v_mov_b32 v25, 0
    v_mov_b32 v26, 0
    v_mov_b32 v27, 0
    v_mov_b32 v28, 0
    v_mov_b32 v29, 0
    v_mov_b32 v30, 0
    v_mov_b32 v31, 0
    s_waitcnt vmcnt(8)
    buffer_load_dwordx4 a[120:123], v1, s[20:23], s50 offen offset:2048 nt
    buffer_load_dwordx4 v3, s[40:43], s56 offen offset:3072 nt lds
    s_waitcnt vmcnt(9)
    buffer_load_dwordx4 a[124:127], v1, s[20:23], s50 offen offset:2304 nt
    s_add_u32 s100, s100, 16384
    s_and_b32 s100, s100, 262143
    s_add_u32 s50, s98, s100
    s_waitcnt vmcnt(8)
    buffer_load_dwordx4 a[128:131], v1, s[20:23], s50 offen offset:0 nt
    s_add_u32 s56, s56, 4096
    s_add_u32 s3, s3, 4096
    s_mov_b32 m0, s3
    s_nop 0
    buffer_load_dwordx4 v3, s[40:43], s56 offen offset:0 nt lds
    s_waitcnt vmcnt(9)
    buffer_load_dwordx4 a[132:135], v1, s[20:23], s50 offen offset:256 nt
    s_waitcnt vmcnt(8)
    buffer_load_dwordx4 a[136:139], v1, s[20:23], s50 offen offset:2048 nt
    buffer_load_dwordx4 v3, s[40:43], s56 offen offset:1024 nt lds
    s_waitcnt vmcnt(7)
    buffer_load_dwordx4 a[140:143], v1, s[20:23], s50 offen offset:2304 nt
    s_add_u32 s100, s100, 16384
    s_and_b32 s100, s100, 262143
    s_add_u32 s50, s98, s100
    s_waitcnt vmcnt(6)
    buffer_load_dwordx4 a[144:147], v1, s[20:23], s50 offen offset:0 nt
    buffer_load_dwordx4 v3, s[40:43], s56 offen offset:2048 nt lds
    s_waitcnt vmcnt(7)
    buffer_load_dwordx4 a[148:151], v1, s[20:23], s50 offen offset:256 nt
    s_waitcnt vmcnt(6)
    buffer_load_dwordx4 a[152:155], v1, s[20:23], s50 offen offset:2048 nt
    buffer_load_dwordx4 v3, s[40:43], s56 offen offset:3072 nt lds
    s_waitcnt vmcnt(7)
    buffer_load_dwordx4 a[156:159], v1, s[20:23], s50 offen offset:2304 nt
    s_add_u32 s100, s100, 16384
    s_and_b32 s100, s100, 262143
    s_add_u32 s50, s98, s100
    s_waitcnt vmcnt(6)
    buffer_load_dwordx4 a[160:163], v1, s[20:23], s50 offen offset:0 nt
    s_add_u32 s56, s56, 4096
    s_add_u32 s3, s3, 4096
    s_mov_b32 m0, s3
    s_nop 0
    buffer_load_dwordx4 v3, s[40:43], s56 offen offset:0 nt lds
    s_waitcnt vmcnt(7)
    buffer_load_dwordx4 a[164:167], v1, s[20:23], s50 offen offset:256 nt
    s_waitcnt vmcnt(6)
    buffer_load_dwordx4 a[168:171], v1, s[20:23], s50 offen offset:2048 nt
    buffer_load_dwordx4 v3, s[40:43], s56 offen offset:1024 nt lds
    buffer_load_dwordx4 v[32:35], v3, s[28:31], s60 offen offset:0 sc1 nt
    buffer_load_dwordx4 v[36:39], v3, s[28:31], s60 offen offset:1024 sc1 nt
    s_waitcnt vmcnt(9)
    buffer_load_dwordx4 a[172:175], v1, s[20:23], s50 offen offset:2304 nt
    s_add_u32 s100, s100, 16384
    s_and_b32 s100, s100, 262143
    s_add_u32 s50, s98, s100
    s_waitcnt vmcnt(8)
    buffer_load_dwordx4 a[176:179], v1, s[20:23], s50 offen offset:0 nt
    buffer_load_dwordx4 v3, s[40:43], s56 offen offset:2048 nt lds
    s_waitcnt vmcnt(9)
    buffer_load_dwordx4 a[180:183], v1, s[20:23], s50 offen offset:256 nt
    s_waitcnt vmcnt(8)
    buffer_load_dwordx4 a[184:187], v1, s[20:23], s50 offen offset:2048 nt
    buffer_load_dwordx4 v3, s[40:43], s56 offen offset:3072 nt lds
    s_waitcnt vmcnt(9)
    buffer_load_dwordx4 a[188:191], v1, s[20:23], s50 offen offset:2304 nt
    s_add_u32 s100, s100, 16384
    s_and_b32 s100, s100, 262143
    s_add_u32 s50, s98, s100
    s_waitcnt vmcnt(7)
    s_mov_b32 s66, 200000
L_q_chk:
    v_perm_b32 v5, v35, v33, s16
    v_perm_b32 v11, v39, v37, s16
    v_xor_b32 v5, s49, v5
    v_xor_b32 v11, s49, v11
    v_or_b32 v5, v5, v11
    v_cmp_ne_u32 vcc, 0, v5
    s_cbranch_vccz L_q_ok
    buffer_load_dwordx4 v[32:35], v3, s[28:31], s60 offen offset:0 sc1 nt
    buffer_load_dwordx4 v[36:39], v3, s[28:31], s60 offen offset:1024 sc1 nt
    s_sub_u32 s66, s66, 1
    s_cmp_eq_u32 s66, 0
    s_cbranch_scc1 L_end
    s_waitcnt vmcnt(0)
    s_branch L_q_chk
L_q_ok:
    v_perm_b32 v33, v33, v32, s15
    v_perm_b32 v35, v35, v34, s15
    v_perm_b32 v37, v37, v36, s15
    v_perm_b32 v39, v39, v38, s15
    v_add_f32 v32, v32, v36
    v_add_f32 v33, v33, v37
    v_add_f32 v34, v34, v38
    v_add_f32 v35, v35, v39
    s_nop 0
    v_permlane32_swap_b32 v32, v34
    v_permlane32_swap_b32 v33, v35
    s_nop 0
    v_add_f32 v32, v32, v34
    v_add_f32 v33, v33, v35
    v_cvt_pk_bf16_f32 v32, v32, v33
    ds_write_b32 v112, v32
    s_waitcnt lgkmcnt(0)
    s_barrier
    s_mov_b32 exec_lo, 0x33333333
    s_mov_b32 exec_hi, 0x33333333
    ds_read_b128 v[16:19], v113 offset:0
    ds_read_b128 v[20:23], v113 offset:256
    s_mov_b32 exec_lo, 0xcccccccc
    s_mov_b32 exec_hi, 0xcccccccc
    ds_read_b128 v[24:27], v113 offset:0
    ds_read_b128 v[28:31], v113 offset:256
    s_mov_b64 exec, -1
    s_waitcnt vmcnt(6)
    buffer_load_dwordx4 a[192:195], v1, s[20:23], s50 offen offset:0 nt
    s_add_u32 s56, s56, 4096
    s_add_u32 s3, s3, 4096
    s_mov_b32 m0, s3
    s_nop 0
    buffer_load_dwordx4 v3, s[40:43], s56 offen offset:0 nt lds
    s_waitcnt lgkmcnt(0)
    v_mfma_f32_16x16x32_bf16 v[64:67], a[0:3], v[16:19], 0
    v_mfma_f32_16x16x32_bf16 v[64:67], a[4:7], v[20:23], v[64:67]
    v_mfma_f32_16x16x32_bf16 v[64:67], a[8:11], v[24:27], v[64:67]
    v_mfma_f32_16x16x32_bf16 v[64:67], a[12:15], v[28:31], v[64:67]
    s_waitcnt vmcnt(7)
    buffer_load_dwordx4 a[196:199], v1, s[20:23], s50 offen offset:256 nt
    v_mfma_f32_16x16x32_bf16 v[68:71], a[16:19], v[16:19], 0
    v_mfma_f32_16x16x32_bf16 v[68:71], a[20:23], v[20:23], v[68:71]
    v_mfma_f32_16x16x32_bf16 v[68:71], a[24:27], v[24:27], v[68:71]
    v_mfma_f32_16x16x32_bf16 v[68:71], a[28:31], v[28:31], v[68:71]
    s_nop 3
    v_add_f32_dpp v76, v65, v64 row_ror:12 row_mask:0xf bank_mask:0x1
    v_mfma_f32_16x16x32_bf16 v[72:75], a[32:35], v[16:19], 0
    v_mfma_f32_16x16x32_bf16 v[72:75], a[36:39], v[20:23], v[72:75]
    v_add_f32_dpp v76, v66, v76 row_ror:8 row_mask:0xf bank_mask:0x1
    v_mfma_f32_16x16x32_bf16 v[72:75], a[40:43], v[24:27], v[72:75]
    v_mfma_f32_16x16x32_bf16 v[72:75], a[44:47], v[28:31], v[72:75]
    v_add_f32_dpp v76, v67, v76 row_ror:4 row_mask:0xf bank_mask:0x1
    s_waitcnt vmcnt(6)
    buffer_load_dwordx4 a[200:203], v1, s[20:23], s50 offen offset:2048 nt
    buffer_load_dwordx4 v3, s[40:43], s56 offen offset:1024 nt lds
    s_nop 0
    v_add_f32_dpp v76, v70, v69 row_ror:12 row_mask:0xf bank_mask:0x2
    v_mfma_f32_16x16x32_bf16 v[64:67], a[48:51], v[16:19], 0
    v_mfma_f32_16x16x32_bf16 v[64:67], a[52:55], v[20:23], v[64:67]
    v_add_f32_dpp v76, v71, v76 row_ror:8 row_mask:0xf bank_mask:0x2
    v_mfma_f32_16x16x32_bf16 v[64:67], a[56:59], v[24:27], v[64:67]
    v_mfma_f32_16x16x32_bf16 v[64:67], a[60:63], v[28:31], v[64:67]
    v_add_f32_dpp v76, v68, v76 row_ror:4 row_mask:0xf bank_mask:0x2
    v_add_f32_dpp v76, v75, v74 row_ror:12 row_mask:0xf bank_mask:0x4
    v_mfma_f32_16x16x32_bf16 v[68:71], a[64:67], v[16:19], 0
    v_mfma_f32_16x16x32_bf16 v[68:71], a[68:71], v[20:23], v[68:71]
    v_add_f32_dpp v76, v72, v76 row_ror:8 row_mask:0xf bank_mask:0x4
    v_mfma_f32_16x16x32_bf16 v[68:71], a[72:75], v[24:27], v[68:71]
    v_mfma_f32_16x16x32_bf16 v[68:71], a[76:79], v[28:31], v[68:71]
    v_add_f32_dpp v76, v73, v76 row_ror:4 row_mask:0xf bank_mask:0x4
    s_waitcnt vmcnt(7)
    buffer_load_dwordx4 a[204:207], v1, s[20:23], s50 offen offset:2304 nt
    s_add_u32 s100, s100, 16384
    s_and_b32 s100, s100, 262143
    s_add_u32 s50, s98, s100
    v_add_f32_dpp v76, v64, v67 row_ror:12 row_mask:0xf bank_mask:0x8
    v_mfma_f32_16x16x32_bf16 v[72:75], a[80:83], v[16:19], 0
    v_mfma_f32_16x16x32_bf16 v[72:75], a[84:87], v[20:23], v[72:75]
    v_add_f32_dpp v76, v65, v76 row_ror:8 row_mask:0xf bank_mask:0x8
    v_mfma_f32_16x16x32_bf16 v[72:75], a[88:91], v[24:27], v[72:75]
    v_mfma_f32_16x16x32_bf16 v[72:75], a[92:95], v[28:31], v[72:75]
    v_add_f32_dpp v76, v66, v76 row_ror:4 row_mask:0xf bank_mask:0x8
    v_add_f32_dpp v77, v69, v68 row_ror:12 row_mask:0xf bank_mask:0x1
    v_mfma_f32_16x16x32_bf16 v[64:67], a[96:99], v[16:19], 0
    v_mfma_f32_16x16x32_bf16 v[64:67], a[100:103], v[20:23], v[64:67]
    v_add_f32_dpp v77, v70, v77 row_ror:8 row_mask:0xf bank_mask:0x1
    v_mfma_f32_16x16x32_bf16 v[64:67], a[104:107], v[24:27], v[64:67]
    v_mfma_f32_16x16x32_bf16 v[64:67], a[108:111], v[28:31], v[64:67]
    v_add_f32_dpp v77, v71, v77 row_ror:4 row_mask:0xf bank_mask:0x1
    s_waitcnt vmcnt(6)
    buffer_load_dwordx4 a[208:211], v1, s[20:23], s50 offen offset:0 nt
    buffer_load_dwordx4 v3, s[40:43], s56 offen offset:2048 nt lds
    v_add_f32_dpp v77, v74, v73 row_ror:12 row_mask:0xf bank_mask:0x2
    v_mfma_f32_16x16x32_bf16 v[68:71], a[112:115], v[16:19], 0
    v_mfma_f32_16x16x32_bf16 v[68:71], a[116:119], v[20:23], v[68:71]
    v_add_f32_dpp v77, v75, v77 row_ror:8 row_mask:0xf bank_mask:0x2
    v_mfma_f32_16x16x32_bf16 v[68:71], a[120:123], v[24:27], v[68:71]
    v_mfma_f32_16x16x32_bf16 v[68:71], a[124:127], v[28:31], v[68:71]
    v_add_f32_dpp v77, v72, v77 row_ror:4 row_mask:0xf bank_mask:0x2
    v_add_f32_dpp v77, v67, v66 row_ror:12 row_mask:0xf bank_mask:0x4
    v_mfma_f32_16x16x32_bf16 v[72:75], a[128:131], v[16:19], 0
    v_mfma_f32_16x16x32_bf16 v[72:75], a[132:135], v[20:23], v[72:75]
    v_add_f32_dpp v77, v64, v77 row_ror:8 row_mask:0xf bank_mask:0x4
    v_mfma_f32_16x16x32_bf16 v[72:75], a[136:139], v[24:27], v[72:75]
    v_mfma_f32_16x16x32_bf16 v[72:75], a[140:143], v[28:31], v[72:75]
    v_add_f32_dpp v77, v65, v77 row_ror:4 row_mask:0xf bank_mask:0x4
    s_waitcnt vmcnt(7)
    buffer_load_dwordx4 a[212:215], v1, s[20:23], s50 offen offset:256 nt
    v_add_f32_dpp v77, v68, v71 row_ror:12 row_mask:0xf bank_mask:0x8
    v_mfma_f32_16x16x32_bf16 v[64:67], a[144:147], v[16:19], 0
    v_mfma_f32_16x16x32_bf16 v[64:67], a[148:151], v[20:23], v[64:67]
    v_add_f32_dpp v77, v69, v77 row_ror:8 row_mask:0xf bank_mask:0x8
    v_mfma_f32_16x16x32_bf16 v[64:67], a[152:155], v[24:27], v[64:67]
    v_mfma_f32_16x16x32_bf16 v[64:67], a[156:159], v[28:31], v[64:67]
    v_add_f32_dpp v77, v70, v77 row_ror:4 row_mask:0xf bank_mask:0x8
    v_add_f32_dpp v78, v73, v72 row_ror:12 row_mask:0xf bank_mask:0x1
    v_mfma_f32_16x16x32_bf16 v[68:71], a[160:163], v[16:19], 0
    v_mfma_f32_16x16x32_bf16 v[68:71], a[164:167], v[20:23], v[68:71]
    v_add_f32_dpp v78, v74, v78 row_ror:8 row_mask:0xf bank_mask:0x1
    v_mfma_f32_16x16x32_bf16 v[68:71], a[168:171], v[24:27], v[68:71]
    v_mfma_f32_16x16x32_bf16 v[68:71], a[172:175], v[28:31], v[68:71]
    v_add_f32_dpp v78, v75, v78 row_ror:4 row_mask:0xf bank_mask:0x1
    s_waitcnt vmcnt(6)
    buffer_load_dwordx4 a[216:219], v1, s[20:23], s50 offen offset:2048 nt
    buffer_load_dwordx4 v3, s[40:43], s56 offen offset:3072 nt lds
    v_add_f32_dpp v78, v66, v65 row_ror:12 row_mask:0xf bank_mask:0x2
    v_mfma_f32_16x16x32_bf16 v[72:75], a[176:179], v[16:19], 0
    v_mfma_f32_16x16x32_bf16 v[72:75], a[180:183], v[20:23], v[72:75]
    v_add_f32_dpp v78, v67, v78 row_ror:8 row_mask:0xf bank_mask:0x2
    v_mfma_f32_16x16x32_bf16 v[72:75], a[184:187], v[24:27], v[72:75]
    v_mfma_f32_16x16x32_bf16 v[72:75], a[188:191], v[28:31], v[72:75]
    v_add_f32_dpp v78, v64, v78 row_ror:4 row_mask:0xf bank_mask:0x2
    s_waitcnt vmcnt(7)
    buffer_load_dwordx4 a[220:223], v1, s[20:23], s50 offen offset:2304 nt
    s_add_u32 s100, s100, 16384
    s_and_b32 s100, s100, 262143
    s_add_u32 s50, s98, s100
    s_waitcnt vmcnt(6)
    buffer_load_dwordx4 a[224:227], v1, s[20:23], s50 offen offset:0 nt
    s_add_u32 s56, s56, 4096
    s_add_u32 s3, s3, 4096
    s_mov_b32 m0, s3
    s_nop 0
    buffer_load_dwordx4 v3, s[40:43], s56 offen offset:0 nt lds
    v_add_f32_dpp v78, v71, v70 row_ror:12 row_mask:0xf bank_mask:0x4
    v_mfma_f32_16x16x32_bf16 v[64:67], a[192:195], v[16:19], 0
    v_mfma_f32_16x16x32_bf16 v[64:67], a[196:199], v[20:23], v[64:67]
    v_add_f32_dpp v78, v68, v78 row_ror:8 row_mask:0xf bank_mask:0x4
    v_mfma_f32_16x16x32_bf16 v[64:67], a[200:203], v[24:27], v[64:67]
    v_mfma_f32_16x16x32_bf16 v[64:67], a[204:207], v[28:31], v[64:67]
    v_add_f32_dpp v78, v69, v78 row_ror:4 row_mask:0xf bank_mask:0x4
    s_waitcnt vmcnt(7)
    buffer_load_dwordx4 a[228:231], v1, s[20:23], s50 offen offset:256 nt
    s_waitcnt vmcnt(6)
    buffer_load_dwordx4 a[232:235], v1, s[20:23], s50 offen offset:2048 nt
    buffer_load_dwordx4 v3, s[40:43], s56 offen offset:1024 nt lds
    s_waitcnt vmcnt(7)
    buffer_load_dwordx4 a[236:239], v1, s[20:23], s50 offen offset:2304 nt
    s_add_u32 s100, s100, 16384
    s_and_b32 s100, s100, 262143
    s_add_u32 s50, s98, s100
    s_waitcnt vmcnt(6)
    buffer_load_dwordx4 a[240:243], v1, s[20:23], s50 offen offset:0 nt
    buffer_load_dwordx4 v3, s[40:43], s56 offen offset:2048 nt lds
    buffer_load_dword v115, v109, s[28:31], s11 offen sc1 nt
    v_add_f32_dpp v78, v72, v75 row_ror:12 row_mask:0xf bank_mask:0x8
    v_mfma_f32_16x16x32_bf16 v[68:71], a[208:211], v[16:19], 0
    v_mfma_f32_16x16x32_bf16 v[68:71], a[212:215], v[20:23], v[68:71]
    v_add_f32_dpp v78, v73, v78 row_ror:8 row_mask:0xf bank_mask:0x8
    v_mfma_f32_16x16x32_bf16 v[68:71], a[216:219], v[24:27], v[68:71]
    v_mfma_f32_16x16x32_bf16 v[68:71], a[220:223], v[28:31], v[68:71]
    v_add_f32_dpp v78, v74, v78 row_ror:4 row_mask:0xf bank_mask:0x8
    s_waitcnt vmcnt(8)
    buffer_load_dwordx4 a[244:247], v1, s[20:23], s50 offen offset:256 nt
    s_waitcnt vmcnt(7)
    buffer_load_dwordx4 a[248:251], v1, s[20:23], s50 offen offset:2048 nt
    buffer_load_dwordx4 v3, s[40:43], s56 offen offset:3072 nt lds
    s_waitcnt vmcnt(8)
    buffer_load_dwordx4 a[252:255], v1, s[20:23], s50 offen offset:2304 nt
    buffer_load_dwordx4 a[0:3], v2, s[24:27], s51 offen nt
    s_add_u32 s51, s51, 16384
    s_waitcnt vmcnt(8)
    buffer_load_dwordx4 a[4:7], v2, s[24:27], s51 offen nt
    s_add_u32 s51, s51, 16384
    v_add_f32_dpp v79, v65, v64 row_ror:12 row_mask:0xf bank_mask:0x1
    v_mfma_f32_16x16x32_bf16 v[72:75], a[224:227], v[16:19], 0
    v_mfma_f32_16x16x32_bf16 v[72:75], a[228:231], v[20:23], v[72:75]
    v_add_f32_dpp v79, v66, v79 row_ror:8 row_mask:0xf bank_mask:0x1
    v_mfma_f32_16x16x32_bf16 v[72:75], a[232:235], v[24:27], v[72:75]
    v_mfma_f32_16x16x32_bf16 v[72:75], a[236:239], v[28:31], v[72:75]
    v_add_f32_dpp v79, v67, v79 row_ror:4 row_mask:0xf bank_mask:0x1
    s_waitcnt vmcnt(8)
    buffer_load_dwordx4 a[8:11], v2, s[24:27], s51 offen nt
    s_add_u32 s51, s51, 16384
    s_waitcnt vmcnt(6)
    buffer_load_dwordx4 a[12:15], v2, s[24:27], s51 offen nt
    s_add_u32 s51, s51, 16384
    s_waitcnt vmcnt(6)
    buffer_load_dwordx4 a[16:19], v2, s[24:27], s51 offen nt
    s_add_u32 s51, s51, 16384
    s_waitcnt vmcnt(5)
    buffer_load_dwordx4 a[20:23], v2, s[24:27], s51 offen nt
    s_add_u32 s51, s51, 16384
    v_add_f32_dpp v79, v70, v69 row_ror:12 row_mask:0xf bank_mask:0x2
    v_mfma_f32_16x16x32_bf16 v[64:67], a[240:243], v[16:19], 0
    v_mfma_f32_16x16x32_bf16 v[64:67], a[244:247], v[20:23], v[64:67]
    v_add_f32_dpp v79, v71, v79 row_ror:8 row_mask:0xf bank_mask:0x2
    v_mfma_f32_16x16x32_bf16 v[64:67], a[248:251], v[24:27], v[64:67]
    v_mfma_f32_16x16x32_bf16 v[64:67], a[252:255], v[28:31], v[64:67]
    v_add_f32_dpp v79, v68, v79 row_ror:4 row_mask:0xf bank_mask:0x2
    s_nop 1
    v_add_f32_dpp v79, v75, v74 row_ror:12 row_mask:0xf bank_mask:0x4
    s_nop 1
    v_add_f32_dpp v79, v72, v79 row_ror:8 row_mask:0xf bank_mask:0x4
    s_nop 1
    v_add_f32_dpp v79, v73, v79 row_ror:4 row_mask:0xf bank_mask:0x4
    s_nop 1
    v_add_f32_dpp v79, v64, v67 row_ror:12 row_mask:0xf bank_mask:0x8
    s_nop 1
    v_add_f32_dpp v79, v65, v79 row_ror:8 row_mask:0xf bank_mask:0x8
    s_nop 1
    v_add_f32_dpp v79, v66, v79 row_ror:4 row_mask:0xf bank_mask:0x8
    v_cvt_pk_bf16_f32 v80, v76, v77
    v_cvt_pk_bf16_f32 v81, v78, v79
    v_min_u32 v80, -2, v80
    v_min_u32 v81, -2, v81
    v_cmp_ne_u32 vcc, s10, v115
    s_cbranch_vccz L_s_fast
    buffer_store_dwordx2 v[80:81], v4, s[28:31], s62 offen sc1 nt
    s_branch L_s_pub
L_s_fast:
    buffer_store_dwordx2 v[80:81], v4, s[28:31], s62 offen
L_s_pub:
    s_waitcnt vmcnt(6)
    buffer_load_dwordx4 a[24:27], v2, s[24:27], s51 offen nt
    s_add_u32 s51, s51, 16384
    v_mov_b64 v[108:109], 0
    v_mov_b64 v[110:111], 0
    v_mov_b64 v[112:113], 0
    v_mov_b64 v[114:115], 0
    v_mov_b64 v[116:117], 0
    v_mov_b64 v[118:119], 0
    v_mov_b64 v[120:121], 0
    v_mov_b64 v[122:123], 0
    v_mov_b64 v[124:125], 0
    v_mov_b64 v[126:127], 0
    v_mov_b64 v[128:129], 0
    v_mov_b64 v[130:131], 0
    v_mov_b64 v[132:133], 0
    v_mov_b64 v[134:135], 0
    v_bfe_u32 v14, v0, 3, 1
    v_mul_u32_u24 v14, 0xaaaa, v14
    v_add_u32 v14, 0x4444, v14
    s_mov_b32 s4, 0x80018001
    s_mov_b32 s5, s4
    v_and_b32 v44, 15, v0
    v_mad_u32_u24 v44, v10, 28, v44
    v_add_lshl_u32 v44, v44, -1, 1
    v_cndmask_b32 v44, v44, -4.0, s[4:5]
    v_mov_b32 v13, s49
    v_mov_b32 v47, 0x403f0000
    v_mov_b32 v12, 1.0
    s_waitcnt vmcnt(6)
    buffer_load_dwordx4 a[28:31], v2, s[24:27], s51 offen nt
    s_add_u32 s51, s51, 16384
    s_waitcnt vmcnt(6)
    buffer_load_dwordx4 a[32:35], v2, s[24:27], s51 offen nt
    s_add_u32 s51, s51, 16384
    s_buffer_load_dword s0, s[28:31], s96 offset:0
    s_waitcnt vmcnt(6)
    buffer_load_dwordx4 a[36:39], v2, s[24:27], s51 offen nt
    s_add_u32 s51, s51, 16384
    s_waitcnt vmcnt(6)
    buffer_load_dwordx4 a[40:43], v2, s[24:27], s51 offen nt
    s_add_u32 s51, s51, 16384
    s_waitcnt vmcnt(6)
    buffer_load_dwordx4 a[44:47], v2, s[24:27], s51 offen nt
    s_add_u32 s51, s51, 16384
    s_waitcnt vmcnt(5)
    buffer_load_dwordx4 a[48:51], v2, s[24:27], s51 offen nt
    s_add_u32 s51, s51, 16384
    s_waitcnt vmcnt(5)
    buffer_load_dwordx4 a[52:55], v2, s[24:27], s51 offen nt
    s_add_u32 s51, s51, 16384
    s_waitcnt vmcnt(5)
    buffer_load_dwordx4 a[56:59], v2, s[24:27], s51 offen nt
    s_add_u32 s51, s51, 16384
    s_waitcnt vmcnt(5)
    buffer_load_dwordx4 a[60:63], v2, s[24:27], s51 offen nt
    s_add_u32 s51, s51, 32768
    s_waitcnt vmcnt(5)
    buffer_load_dwordx4 a[64:67], v2, s[24:27], s51 offen nt
    s_add_u32 s51, s51, 16384
    s_waitcnt vmcnt(5)
    buffer_load_dwordx4 a[68:71], v2, s[24:27], s51 offen nt
    s_add_u32 s51, s51, 16384
    s_waitcnt vmcnt(5)
    buffer_load_dwordx4 a[72:75], v2, s[24:27], s51 offen nt
    s_add_u32 s51, s51, 16384
    s_waitcnt vmcnt(5)
    buffer_load_dwordx4 a[76:79], v2, s[24:27], s51 offen nt
    s_add_u32 s51, s51, 16384
    s_waitcnt vmcnt(5)
    buffer_load_dwordx4 a[80:83], v2, s[24:27], s51 offen nt
    s_add_u32 s51, s51, 16384
    s_waitcnt vmcnt(5)
    buffer_load_dwordx4 a[84:87], v2, s[24:27], s51 offen nt
    s_add_u32 s51, s51, 16384
    s_waitcnt vmcnt(5)
    buffer_load_dwordx4 a[88:91], v2, s[24:27], s51 offen nt
    s_add_u32 s51, s51, 16384
    s_waitcnt vmcnt(5)
    buffer_load_dwordx4 a[92:95], v2, s[24:27], s51 offen nt
    s_add_u32 s51, s51, 16384
    s_waitcnt vmcnt(5)
    buffer_load_dwordx4 a[96:99], v2, s[24:27], s51 offen nt
    s_add_u32 s51, s51, 16384
    buffer_load_dwordx2 v[32:33], v4, s[28:31], s61 offen offset:0 sc1 nt
    buffer_load_dwordx2 v[34:35], v4, s[28:31], s61 offen offset:512 sc1 nt
    buffer_load_dwordx2 v[36:37], v4, s[28:31], s61 offen offset:1024 sc1 nt
    buffer_load_dwordx2 v[38:39], v4, s[28:31], s61 offen offset:1536 sc1 nt
    s_waitcnt vmcnt(9)
    buffer_load_dwordx4 a[100:103], v2, s[24:27], s51 offen nt
    s_add_u32 s51, s51, 16384
    s_waitcnt vmcnt(9)
    buffer_load_dwordx4 a[104:107], v2, s[24:27], s51 offen nt
    s_add_u32 s51, s51, 16384
    s_waitcnt vmcnt(9)
    buffer_load_dwordx4 a[108:111], v2, s[24:27], s51 offen nt
    s_add_u32 s51, s51, 16384
    s_waitcnt vmcnt(9)
    buffer_load_dwordx4 a[112:115], v2, s[24:27], s51 offen nt
    s_add_u32 s51, s51, 16384
    s_waitcnt vmcnt(9)
    buffer_load_dwordx4 a[116:119], v2, s[24:27], s51 offen nt
    s_add_u32 s51, s51, 16384
    s_waitcnt vmcnt(9)
    buffer_load_dwordx4 a[120:123], v2, s[24:27], s51 offen nt
    s_sub_u32 s51, s51, 245760
    s_waitcnt vmcnt(6)
    s_mov_b32 s66, 200000
L_s_chk:
    v_max3_u32 v5, v32, v33, v34
    v_max3_u32 v11, v35, v36, v37
    v_max3_u32 v5, v5, v38, v39
    v_max_u32 v5, v5, v11
    v_cmp_eq_u32 vcc, -1, v5
    s_cbranch_vccz L_s_ok
    buffer_load_dwordx2 v[32:33], v4, s[28:31], s61 offen offset:0 sc1 nt
    buffer_load_dwordx2 v[34:35], v4, s[28:31], s61 offen offset:512 sc1 nt
    buffer_load_dwordx2 v[36:37], v4, s[28:31], s61 offen offset:1024 sc1 nt
    buffer_load_dwordx2 v[38:39], v4, s[28:31], s61 offen offset:1536 sc1 nt
    s_sub_u32 s66, s66, 1
    s_cmp_eq_u32 s66, 0
    s_cbranch_scc1 L_end
    s_waitcnt vmcnt(0)
    s_branch L_s_chk
L_s_ok:
    v_lshlrev_b32 v48, 16, v32
    v_and_b32 v49, 0xffff0000, v32
    v_lshlrev_b32 v50, 16, v33
    v_and_b32 v51, 0xffff0000, v33
    v_lshlrev_b32 v52, 16, v34
    v_and_b32 v53, 0xffff0000, v34
    v_lshlrev_b32 v54, 16, v35
    v_and_b32 v55, 0xffff0000, v35
    v_lshlrev_b32 v56, 16, v36
    v_and_b32 v57, 0xffff0000, v36
    v_lshlrev_b32 v58, 16, v37
    v_and_b32 v59, 0xffff0000, v37
    v_lshlrev_b32 v60, 16, v38
    v_and_b32 v61, 0xffff0000, v38
    v_lshlrev_b32 v62, 16, v39
    v_and_b32 v63, 0xffff0000, v39
    v_max3_f32 v68, v48, v49, v50
    v_max3_f32 v68, v68, v51, v52
    v_max3_f32 v68, v68, v53, v54
    v_max3_f32 v68, v68, v55, v56
    v_max3_f32 v68, v68, v57, v58
    v_max3_f32 v68, v68, v59, v60
    v_max3_f32 v68, v68, v61, v62
    v_max_f32 v68, v68, v63
    s_nop 1
    v_max_f32_dpp v68, v68, v68 row_ror:8 row_mask:0xf bank_mask:0xf
    s_nop 1
    v_max_f32_dpp v68, v68, v68 row_ror:4 row_mask:0xf bank_mask:0xf
    s_nop 1
    v_max_f32_dpp v68, v68, v68 row_ror:2 row_mask:0xf bank_mask:0xf
    s_waitcnt vmcnt(5)
    buffer_load_dwordx4 a[124:127], v2, s[24:27], s51 offen nt
    s_add_u32 s51, s51, 294912
    v_mul_f32 v66, s67, v68
    v_fma_f32 v48, v48, s67, -v66
    v_fma_f32 v49, v49, s67, -v66
    v_fma_f32 v50, v50, s67, -v66
    v_fma_f32 v51, v51, s67, -v66
    v_fma_f32 v52, v52, s67, -v66
    v_fma_f32 v53, v53, s67, -v66
    v_fma_f32 v54, v54, s67, -v66
    v_fma_f32 v55, v55, s67, -v66
    v_fma_f32 v56, v56, s67, -v66
    v_fma_f32 v57, v57, s67, -v66
    v_fma_f32 v58, v58, s67, -v66
    v_fma_f32 v59, v59, s67, -v66
    v_fma_f32 v60, v60, s67, -v66
    v_fma_f32 v61, v61, s67, -v66
    v_fma_f32 v62, v62, s67, -v66
    v_fma_f32 v63, v63, s67, -v66
    v_exp_f32 v48, v48
    v_exp_f32 v49, v49
    v_exp_f32 v50, v50
    v_exp_f32 v51, v51
    v_exp_f32 v52, v52
    v_exp_f32 v53, v53
    v_exp_f32 v54, v54
    v_exp_f32 v55, v55
    v_exp_f32 v56, v56
    v_exp_f32 v57, v57
    v_exp_f32 v58, v58
    v_exp_f32 v59, v59
    v_exp_f32 v60, v60
    v_exp_f32 v61, v61
    v_exp_f32 v62, v62
    v_exp_f32 v63, v63
    v_add_f32 v69, v48, v49
    v_add_f32 v69, v69, v50
    v_add_f32 v69, v69, v51
    v_add_f32 v69, v69, v52
    v_add_f32 v69, v69, v53
    v_add_f32 v69, v69, v54
    v_add_f32 v69, v69, v55
    v_add_f32 v69, v69, v56
    v_add_f32 v69, v69, v57
    v_add_f32 v69, v69, v58
    v_add_f32 v69, v69, v59
    v_add_f32 v69, v69, v60
    v_add_f32 v69, v69, v61
    v_add_f32 v69, v69, v62
    v_add_f32 v69, v69, v63
    s_waitcnt vmcnt(5)
    buffer_load_dwordx4 a[128:131], v2, s[24:27], s51 offen nt
    s_add_u32 s51, s51, 16384
    s_nop 1
    v_add_f32_dpp v69, v69, v69 row_ror:8 row_mask:0xf bank_mask:0xf
    s_nop 1
    v_add_f32_dpp v69, v69, v69 row_ror:4 row_mask:0xf bank_mask:0xf
    s_nop 1
    v_add_f32_dpp v69, v69, v69 row_ror:2 row_mask:0xf bank_mask:0xf
    s_mov_b32 exec_lo, 0x00030003
    s_mov_b32 exec_hi, 0x00030003
    ds_write_b64 v142, v[68:69]
    s_mov_b64 exec, -1
    s_waitcnt lgkmcnt(0)
    s_barrier
    ds_read_b128 v[72:75], v143
    v_mov_b32 v15, s0
    s_mov_b32 s66, 200000
L_f_chk:
    v_cmp_ne_u32 vcc, s49, v15
    s_cbranch_vccz L_f_ok
    buffer_load_dword v15, off, s[28:31], s96 offset:0 sc1 nt
    s_sub_u32 s66, s66, 1
    s_cmp_eq_u32 s66, 0
    s_cbranch_scc1 L_end
    s_waitcnt vmcnt(0)
    s_branch L_f_chk
L_f_ok:
    s_waitcnt vmcnt(5)
    buffer_load_dwordx4 a[132:135], v2, s[24:27], s51 offen nt
    s_add_u32 s51, s51, 16384
    s_waitcnt lgkmcnt(0)
    v_max_f32 v76, v72, v74
    s_nop 1
    v_max_f32_dpp v76, v76, v76 row_ror:8 row_mask:0xf bank_mask:0xf
    s_nop 1
    v_max_f32_dpp v76, v76, v76 row_ror:4 row_mask:0xf bank_mask:0xf
    s_nop 1
    v_max_f32_dpp v76, v76, v76 row_ror:2 row_mask:0xf bank_mask:0xf
    v_sub_f32 v72, v72, v76
    v_sub_f32 v74, v74, v76
    v_sub_f32 v68, v68, v76
    v_mul_f32 v72, s67, v72
    v_mul_f32 v74, s67, v74
    v_mul_f32 v68, s67, v68
    v_exp_f32 v72, v72
    v_exp_f32 v74, v74
    v_exp_f32 v68, v68
    v_mul_f32 v73, v72, v73
    v_fma_f32 v73, v74, v75, v73
    s_nop 1
    v_add_f32_dpp v73, v73, v73 row_ror:8 row_mask:0xf bank_mask:0xf
    s_nop 1
    v_add_f32_dpp v73, v73, v73 row_ror:4 row_mask:0xf bank_mask:0xf
    s_nop 1
    v_add_f32_dpp v73, v73, v73 row_ror:2 row_mask:0xf bank_mask:0xf
    v_rcp_f32 v73, v73
    s_nop 0
    v_mul_f32 v68, v68, v73
    s_waitcnt vmcnt(5)
    buffer_load_dwordx4 a[136:139], v2, s[24:27], s51 offen nt
    s_add_u32 s51, s51, 16384
    v_mul_f32 v48, v48, v68
    v_mul_f32 v49, v49, v68
    v_mul_f32 v50, v50, v68
    v_mul_f32 v51, v51, v68
    v_mul_f32 v52, v52, v68
    v_mul_f32 v53, v53, v68
    v_mul_f32 v54, v54, v68
    v_mul_f32 v55, v55, v68
    v_mul_f32 v56, v56, v68
    v_mul_f32 v57, v57, v68
    v_mul_f32 v58, v58, v68
    v_mul_f32 v59, v59, v68
    v_mul_f32 v60, v60, v68
    v_mul_f32 v61, v61, v68
    v_mul_f32 v62, v62, v68
    v_mul_f32 v63, v63, v68
    v_cvt_pk_bf16_f32 v48, v48, v48
    v_cvt_pk_bf16_f32 v49, v49, v49
    v_cvt_pk_bf16_f32 v50, v50, v50
    v_cvt_pk_bf16_f32 v51, v51, v51
    v_cvt_pk_bf16_f32 v52, v52, v52
    v_cvt_pk_bf16_f32 v53, v53, v53
    v_cvt_pk_bf16_f32 v54, v54, v54
    v_cvt_pk_bf16_f32 v55, v55, v55
    v_cvt_pk_bf16_f32 v56, v56, v56
    v_cvt_pk_bf16_f32 v57, v57, v57
    v_cvt_pk_bf16_f32 v58, v58, v58
    v_cvt_pk_bf16_f32 v59, v59, v59
    v_cvt_pk_bf16_f32 v60, v60, v60
    v_cvt_pk_bf16_f32 v61, v61, v61
    v_cvt_pk_bf16_f32 v62, v62, v62
    v_cvt_pk_bf16_f32 v63, v63, v63
    ds_write_b32 v136, v48 offset:0
    ds_write_b32 v136, v49 offset:32
    ds_write_b32 v136, v50 offset:64
    ds_write_b32 v136, v51 offset:96
    ds_write_b32 v136, v52 offset:128
    ds_write_b32 v136, v53 offset:160
    ds_write_b32 v136, v54 offset:192
    ds_write_b32 v136, v55 offset:224
    ds_write_b32 v136, v56 offset:256
    ds_write_b32 v136, v57 offset:288
    ds_write_b32 v136, v58 offset:320
    ds_write_b32 v136, v59 offset:352
    ds_write_b32 v136, v60 offset:384
    ds_write_b32 v136, v61 offset:416
    ds_write_b32 v136, v62 offset:448
    ds_write_b32 v136, v63 offset:480
    s_waitcnt vmcnt(5)
    buffer_load_dwordx4 a[140:143], v2, s[24:27], s51 offen nt
    s_add_u32 s51, s51, 16384
    s_waitcnt lgkmcnt(0)
    ds_read_b128 v[100:103], v137
    s_waitcnt lgkmcnt(0)
    v_and_b32 v92, v100, v6
    v_and_b32 v93, v100, v7
    v_and_b32 v94, v100, v8
    v_and_b32 v95, v100, v9
    s_waitcnt vmcnt(5)
    buffer_load_dwordx4 a[144:147], v2, s[24:27], s51 offen nt
    s_add_u32 s51, s51, 16384
    ds_read_b64_tr_b16 v[144:145], v138 offset:0
    ds_read_b64_tr_b16 v[146:147], v138 offset:3584
    ds_read_b64_tr_b16 v[148:149], v138 offset:28672
    ds_read_b64_tr_b16 v[150:151], v138 offset:32256
    ds_read_b128 v[104:107], v137 offset:16
    v_and_b32 v96, v101, v6
    v_and_b32 v97, v101, v7
    v_and_b32 v98, v101, v8
    v_and_b32 v99, v101, v9
    v_mfma_f32_16x16x32_bf16 v[84:87], v[92:95], a[0:3], 0
    v_and_b32 v92, v102, v6
    v_and_b32 v93, v102, v7
    v_and_b32 v94, v102, v8
    v_and_b32 v95, v102, v9
    v_mfma_f32_16x16x32_bf16 v[88:91], v[96:99], a[0:3], 0
    v_and_b32 v96, v103, v6
    v_and_b32 v97, v103, v7
    v_and_b32 v98, v103, v8
    v_and_b32 v99, v103, v9
    v_mfma_f32_16x16x32_bf16 v[84:87], v[92:95], a[4:7], v[84:87]
    s_waitcnt lgkmcnt(0)
    v_and_b32 v92, v104, v6
    v_and_b32 v93, v104, v7
    v_and_b32 v94, v104, v8
    v_and_b32 v95, v104, v9
    v_mfma_f32_16x16x32_bf16 v[88:91], v[96:99], a[4:7], v[88:91]
    ds_read_b128 v[100:103], v137 offset:32
    v_and_b32 v96, v105, v6
    v_and_b32 v97, v105, v7
    v_and_b32 v98, v105, v8
    v_and_b32 v99, v105, v9
    v_mfma_f32_16x16x32_bf16 v[84:87], v[92:95], a[8:11], v[84:87]
    v_and_b32 v92, v106, v6
    v_and_b32 v93, v106, v7
    v_and_b32 v94, v106, v8
    v_and_b32 v95, v106, v9
    v_mfma_f32_16x16x32_bf16 v[88:91], v[96:99], a[8:11], v[88:91]
    v_and_b32 v96, v107, v6
    v_and_b32 v97, v107, v7
    v_and_b32 v98, v107, v8
    v_and_b32 v99, v107, v9
    v_mfma_f32_16x16x32_bf16 v[84:87], v[92:95], a[12:15], v[84:87]
    s_waitcnt lgkmcnt(0)
    v_and_b32 v92, v100, v6
    v_and_b32 v93, v100, v7
    v_and_b32 v94, v100, v8
    v_and_b32 v95, v100, v9
    v_mfma_f32_16x16x32_bf16 v[88:91], v[96:99], a[12:15], v[88:91]
    s_waitcnt vmcnt(5)
    buffer_load_dwordx4 a[148:151], v2, s[24:27], s51 offen nt
    s_add_u32 s51, s51, 16384
    ds_read_b64_tr_b16 v[152:153], v139 offset:0
    ds_read_b64_tr_b16 v[154:155], v139 offset:3584
    ds_read_b64_tr_b16 v[156:157], v139 offset:28672
    ds_read_b64_tr_b16 v[158:159], v139 offset:32256
    ds_read_b128 v[104:107], v137 offset:48
    v_and_b32 v96, v101, v6
    v_and_b32 v97, v101, v7
    v_and_b32 v98, v101, v8
    v_and_b32 v99, v101, v9
    v_mfma_f32_16x16x32_bf16 v[84:87], v[92:95], a[16:19], v[84:87]
    v_and_b32 v92, v102, v6
    v_and_b32 v93, v102, v7
    v_and_b32 v94, v102, v8
    v_and_b32 v95, v102, v9
    v_mfma_f32_16x16x32_bf16 v[88:91], v[96:99], a[16:19], v[88:91]
    v_and_b32 v96, v103, v6
    v_and_b32 v97, v103, v7
    v_and_b32 v98, v103, v8
    v_and_b32 v99, v103, v9
    v_mfma_f32_16x16x32_bf16 v[84:87], v[92:95], a[20:23], v[84:87]
    s_waitcnt lgkmcnt(0)
    v_and_b32 v92, v104, v6
    v_and_b32 v93, v104, v7
    v_and_b32 v94, v104, v8
    v_and_b32 v95, v104, v9
    v_mfma_f32_16x16x32_bf16 v[88:91], v[96:99], a[20:23], v[88:91]
    ds_read_b128 v[100:103], v137 offset:64
    v_and_b32 v96, v105, v6
    v_and_b32 v97, v105, v7
    v_and_b32 v98, v105, v8
    v_and_b32 v99, v105, v9
    v_mfma_f32_16x16x32_bf16 v[84:87], v[92:95], a[24:27], v[84:87]
    v_and_b32 v92, v106, v6
    v_and_b32 v93, v106, v7
    v_and_b32 v94, v106, v8
    v_and_b32 v95, v106, v9
    v_mfma_f32_16x16x32_bf16 v[88:91], v[96:99], a[24:27], v[88:91]
    v_and_b32 v96, v107, v6
    v_and_b32 v97, v107, v7
    v_and_b32 v98, v107, v8
    v_and_b32 v99, v107, v9
    v_mfma_f32_16x16x32_bf16 v[84:87], v[92:95], a[28:31], v[84:87]
    s_waitcnt lgkmcnt(0)
    v_and_b32 v92, v100, v6
    v_and_b32 v93, v100, v7
    v_and_b32 v94, v100, v8
    v_and_b32 v95, v100, v9
    v_mfma_f32_16x16x32_bf16 v[88:91], v[96:99], a[28:31], v[88:91]
    s_waitcnt vmcnt(5)
    buffer_load_dwordx4 a[152:155], v2, s[24:27], s51 offen nt
    s_add_u32 s51, s51, 16384
    ds_read_b64_tr_b16 v[160:161], v138 offset:24
    ds_read_b64_tr_b16 v[162:163], v138 offset:3608
    ds_read_b64_tr_b16 v[164:165], v138 offset:28696
    ds_read_b64_tr_b16 v[166:167], v138 offset:32280
    ds_read_b128 v[104:107], v137 offset:80
    v_and_b32 v96, v101, v6
    v_and_b32 v97, v101, v7
    v_and_b32 v98, v101, v8
    v_and_b32 v99, v101, v9
    v_mfma_f32_16x16x32_bf16 v[84:87], v[92:95], a[32:35], v[84:87]
    v_and_b32 v92, v102, v6
    v_and_b32 v93, v102, v7
    v_and_b32 v94, v102, v8
    v_and_b32 v95, v102, v9
    v_mfma_f32_16x16x32_bf16 v[88:91], v[96:99], a[32:35], v[88:91]
    v_and_b32 v96, v103, v6
    v_and_b32 v97, v103, v7
    v_and_b32 v98, v103, v8
    v_and_b32 v99, v103, v9
    v_mfma_f32_16x16x32_bf16 v[84:87], v[92:95], a[36:39], v[84:87]
    s_waitcnt lgkmcnt(0)
    v_and_b32 v92, v104, v6
    v_and_b32 v93, v104, v7
    v_and_b32 v94, v104, v8
    v_and_b32 v95, v104, v9
    v_mfma_f32_16x16x32_bf16 v[88:91], v[96:99], a[36:39], v[88:91]
    ds_read_b128 v[100:103], v137 offset:96
    v_and_b32 v96, v105, v6
    v_and_b32 v97, v105, v7
    v_and_b32 v98, v105, v8
    v_and_b32 v99, v105, v9
    v_mfma_f32_16x16x32_bf16 v[84:87], v[92:95], a[40:43], v[84:87]
    v_and_b32 v92, v106, v6
    v_and_b32 v93, v106, v7
    v_and_b32 v94, v106, v8
    v_and_b32 v95, v106, v9
    v_mfma_f32_16x16x32_bf16 v[88:91], v[96:99], a[40:43], v[88:91]
    v_and_b32 v96, v107, v6
    v_and_b32 v97, v107, v7
    v_and_b32 v98, v107, v8
    v_and_b32 v99, v107, v9
    v_mfma_f32_16x16x32_bf16 v[84:87], v[92:95], a[44:47], v[84:87]
    s_waitcnt lgkmcnt(0)
    v_and_b32 v92, v100, v6
    v_and_b32 v93, v100, v7
    v_and_b32 v94, v100, v8
    v_and_b32 v95, v100, v9
    v_mfma_f32_16x16x32_bf16 v[88:91], v[96:99], a[44:47], v[88:91]
    s_waitcnt vmcnt(5)
    buffer_load_dwordx4 a[156:159], v2, s[24:27], s51 offen nt
    s_add_u32 s51, s51, 16384
    ds_read_b64_tr_b16 v[168:169], v139 offset:24
    ds_read_b64_tr_b16 v[170:171], v139 offset:3608
    ds_read_b64_tr_b16 v[172:173], v139 offset:28696
    ds_read_b64_tr_b16 v[174:175], v139 offset:32280
    ds_read_b128 v[104:107], v137 offset:112
    v_and_b32 v96, v101, v6
    v_and_b32 v97, v101, v7
    v_and_b32 v98, v101, v8
    v_and_b32 v99, v101, v9
    v_mfma_f32_16x16x32_bf16 v[84:87], v[92:95], a[48:51], v[84:87]
    v_and_b32 v92, v102, v6
    v_and_b32 v93, v102, v7
    v_and_b32 v94, v102, v8
    v_and_b32 v95, v102, v9
    v_mfma_f32_16x16x32_bf16 v[88:91], v[96:99], a[48:51], v[88:91]
    v_and_b32 v96, v103, v6
    v_and_b32 v97, v103, v7
    v_and_b32 v98, v103, v8
    v_and_b32 v99, v103, v9
    v_mfma_f32_16x16x32_bf16 v[84:87], v[92:95], a[52:55], v[84:87]
    s_waitcnt lgkmcnt(0)
    v_and_b32 v92, v104, v6
    v_and_b32 v93, v104, v7
    v_and_b32 v94, v104, v8
    v_and_b32 v95, v104, v9
    v_mfma_f32_16x16x32_bf16 v[88:91], v[96:99], a[52:55], v[88:91]
    ds_read_b128 v[100:103], v137 offset:128
    v_and_b32 v96, v105, v6
    v_and_b32 v97, v105, v7
    v_and_b32 v98, v105, v8
    v_and_b32 v99, v105, v9
    v_mfma_f32_16x16x32_bf16 v[84:87], v[92:95], a[56:59], v[84:87]
    v_and_b32 v92, v106, v6
    v_and_b32 v93, v106, v7
    v_and_b32 v94, v106, v8
    v_and_b32 v95, v106, v9
    v_mfma_f32_16x16x32_bf16 v[88:91], v[96:99], a[56:59], v[88:91]
    v_and_b32 v96, v107, v6
    v_and_b32 v97, v107, v7
    v_and_b32 v98, v107, v8
    v_and_b32 v99, v107, v9
    v_mfma_f32_16x16x32_bf16 v[84:87], v[92:95], a[60:63], v[84:87]
    s_waitcnt lgkmcnt(0)
    v_and_b32 v92, v100, v6
    v_and_b32 v93, v100, v7
    v_and_b32 v94, v100, v8
    v_and_b32 v95, v100, v9
    v_mfma_f32_16x16x32_bf16 v[88:91], v[96:99], a[60:63], v[88:91]
    s_waitcnt vmcnt(5)
    buffer_load_dwordx4 a[160:163], v2, s[24:27], s51 offen nt
    s_add_u32 s51, s51, 16384
    ds_read_b64_tr_b16 v[176:177], v138 offset:56
    ds_read_b64_tr_b16 v[178:179], v138 offset:3640
    ds_read_b64_tr_b16 v[180:181], v138 offset:28728
    ds_read_b64_tr_b16 v[182:183], v138 offset:32312
    ds_read_b128 v[104:107], v137 offset:144
    v_and_b32 v96, v101, v6
    v_and_b32 v97, v101, v7
    v_and_b32 v98, v101, v8
    v_and_b32 v99, v101, v9
    v_mfma_f32_16x16x32_bf16 v[84:87], v[92:95], a[64:67], v[84:87]
    v_and_b32 v92, v102, v6
    v_and_b32 v93, v102, v7
    v_and_b32 v94, v102, v8
    v_and_b32 v95, v102, v9
    v_mfma_f32_16x16x32_bf16 v[88:91], v[96:99], a[64:67], v[88:91]
    v_and_b32 v96, v103, v6
    v_and_b32 v97, v103, v7
    v_and_b32 v98, v103, v8
    v_and_b32 v99, v103, v9
    v_mfma_f32_16x16x32_bf16 v[84:87], v[92:95], a[68:71], v[84:87]
    s_waitcnt lgkmcnt(0)
    v_and_b32 v92, v104, v6
    v_and_b32 v93, v104, v7
    v_and_b32 v94, v104, v8
    v_and_b32 v95, v104, v9
    v_mfma_f32_16x16x32_bf16 v[88:91], v[96:99], a[68:71], v[88:91]
    ds_read_b128 v[100:103], v137 offset:160
    v_and_b32 v96, v105, v6
    v_and_b32 v97, v105, v7
    v_and_b32 v98, v105, v8
    v_and_b32 v99, v105, v9
    v_mfma_f32_16x16x32_bf16 v[84:87], v[92:95], a[72:75], v[84:87]
    v_and_b32 v92, v106, v6
    v_and_b32 v93, v106, v7
    v_and_b32 v94, v106, v8
    v_and_b32 v95, v106, v9
    v_mfma_f32_16x16x32_bf16 v[88:91], v[96:99], a[72:75], v[88:91]
    v_and_b32 v96, v107, v6
    v_and_b32 v97, v107, v7
    v_and_b32 v98, v107, v8
    v_and_b32 v99, v107, v9
    v_mfma_f32_16x16x32_bf16 v[84:87], v[92:95], a[76:79], v[84:87]
    s_waitcnt lgkmcnt(0)
    v_and_b32 v92, v100, v6
    v_and_b32 v93, v100, v7
    v_and_b32 v94, v100, v8
    v_and_b32 v95, v100, v9
    v_mfma_f32_16x16x32_bf16 v[88:91], v[96:99], a[76:79], v[88:91]
    s_waitcnt vmcnt(5)
    buffer_load_dwordx4 a[164:167], v2, s[24:27], s51 offen nt
    s_add_u32 s51, s51, 16384
    ds_read_b64_tr_b16 v[184:185], v139 offset:56
    ds_read_b64_tr_b16 v[186:187], v139 offset:3640
    ds_read_b64_tr_b16 v[188:189], v139 offset:28728
    ds_read_b64_tr_b16 v[190:191], v139 offset:32312
    ds_read_b128 v[104:107], v137 offset:176
    v_and_b32 v96, v101, v6
    v_and_b32 v97, v101, v7
    v_and_b32 v98, v101, v8
    v_and_b32 v99, v101, v9
    v_mfma_f32_16x16x32_bf16 v[84:87], v[92:95], a[80:83], v[84:87]
    v_and_b32 v92, v102, v6
    v_and_b32 v93, v102, v7
    v_and_b32 v94, v102, v8
    v_and_b32 v95, v102, v9
    v_mfma_f32_16x16x32_bf16 v[88:91], v[96:99], a[80:83], v[88:91]
    v_and_b32 v96, v103, v6
    v_and_b32 v97, v103, v7
    v_and_b32 v98, v103, v8
    v_and_b32 v99, v103, v9
    v_mfma_f32_16x16x32_bf16 v[84:87], v[92:95], a[84:87], v[84:87]
    s_waitcnt lgkmcnt(0)
    v_and_b32 v92, v104, v6
    v_and_b32 v93, v104, v7
    v_and_b32 v94, v104, v8
    v_and_b32 v95, v104, v9
    v_mfma_f32_16x16x32_bf16 v[88:91], v[96:99], a[84:87], v[88:91]
    ds_read_b128 v[100:103], v137 offset:192
    v_and_b32 v96, v105, v6
    v_and_b32 v97, v105, v7
    v_and_b32 v98, v105, v8
    v_and_b32 v99, v105, v9
    v_mfma_f32_16x16x32_bf16 v[84:87], v[92:95], a[88:91], v[84:87]
    v_and_b32 v92, v106, v6
    v_and_b32 v93, v106, v7
    v_and_b32 v94, v106, v8
    v_and_b32 v95, v106, v9
    v_mfma_f32_16x16x32_bf16 v[88:91], v[96:99], a[88:91], v[88:91]
    v_and_b32 v96, v107, v6
    v_and_b32 v97, v107, v7
    v_and_b32 v98, v107, v8
    v_and_b32 v99, v107, v9
    v_mfma_f32_16x16x32_bf16 v[84:87], v[92:95], a[92:95], v[84:87]
    s_waitcnt lgkmcnt(0)
    v_and_b32 v92, v100, v6
    v_and_b32 v93, v100, v7
    v_and_b32 v94, v100, v8
    v_and_b32 v95, v100, v9
    v_mfma_f32_16x16x32_bf16 v[88:91], v[96:99], a[92:95], v[88:91]
    s_waitcnt vmcnt(5)
    buffer_load_dwordx4 a[168:171], v2, s[24:27], s51 offen nt
    s_add_u32 s51, s51, 16384
    ds_read_b64_tr_b16 v[192:193], v138 offset:80
    ds_read_b64_tr_b16 v[194:195], v138 offset:3664
    ds_read_b64_tr_b16 v[196:197], v138 offset:28752
    ds_read_b64_tr_b16 v[198:199], v138 offset:32336
    ds_read_b128 v[104:107], v137 offset:208
    v_and_b32 v96, v101, v6
    v_and_b32 v97, v101, v7
    v_and_b32 v98, v101, v8
    v_and_b32 v99, v101, v9
    v_mfma_f32_16x16x32_bf16 v[84:87], v[92:95], a[96:99], v[84:87]
    v_and_b32 v92, v102, v6
    v_and_b32 v93, v102, v7
    v_and_b32 v94, v102, v8
    v_and_b32 v95, v102, v9
    v_mfma_f32_16x16x32_bf16 v[88:91], v[96:99], a[96:99], v[88:91]
    v_and_b32 v96, v103, v6
    v_and_b32 v97, v103, v7
    v_and_b32 v98, v103, v8
    v_and_b32 v99, v103, v9
    v_mfma_f32_16x16x32_bf16 v[84:87], v[92:95], a[100:103], v[84:87]
    s_waitcnt lgkmcnt(0)
    v_and_b32 v92, v104, v6
    v_and_b32 v93, v104, v7
    v_and_b32 v94, v104, v8
    v_and_b32 v95, v104, v9
    v_mfma_f32_16x16x32_bf16 v[88:91], v[96:99], a[100:103], v[88:91]
    ds_read_b128 v[100:103], v137 offset:224
    v_and_b32 v96, v105, v6
    v_and_b32 v97, v105, v7
    v_and_b32 v98, v105, v8
    v_and_b32 v99, v105, v9
    v_mfma_f32_16x16x32_bf16 v[84:87], v[92:95], a[104:107], v[84:87]
    v_and_b32 v92, v106, v6
    v_and_b32 v93, v106, v7
    v_and_b32 v94, v106, v8
    v_and_b32 v95, v106, v9
    v_mfma_f32_16x16x32_bf16 v[88:91], v[96:99], a[104:107], v[88:91]
    v_and_b32 v96, v107, v6
    v_and_b32 v97, v107, v7
    v_and_b32 v98, v107, v8
    v_and_b32 v99, v107, v9
    v_mfma_f32_16x16x32_bf16 v[84:87], v[92:95], a[108:111], v[84:87]
    s_waitcnt lgkmcnt(0)
    v_and_b32 v92, v100, v6
    v_and_b32 v93, v100, v7
    v_and_b32 v94, v100, v8
    v_and_b32 v95, v100, v9
    v_mfma_f32_16x16x32_bf16 v[88:91], v[96:99], a[108:111], v[88:91]
    s_waitcnt vmcnt(5)
    buffer_load_dwordx4 a[172:175], v2, s[24:27], s51 offen nt
    s_add_u32 s51, s51, 16384
    ds_read_b64_tr_b16 v[200:201], v139 offset:80
    ds_read_b64_tr_b16 v[202:203], v139 offset:3664
    ds_read_b64_tr_b16 v[204:205], v139 offset:28752
    ds_read_b64_tr_b16 v[206:207], v139 offset:32336
    ds_read_b128 v[104:107], v137 offset:240
    v_and_b32 v96, v101, v6
    v_and_b32 v97, v101, v7
    v_and_b32 v98, v101, v8
    v_and_b32 v99, v101, v9
    v_mfma_f32_16x16x32_bf16 v[84:87], v[92:95], a[112:115], v[84:87]
    v_and_b32 v92, v102, v6
    v_and_b32 v93, v102, v7
    v_and_b32 v94, v102, v8
    v_and_b32 v95, v102, v9
    v_mfma_f32_16x16x32_bf16 v[88:91], v[96:99], a[112:115], v[88:91]
    v_and_b32 v96, v103, v6
    v_and_b32 v97, v103, v7
    v_and_b32 v98, v103, v8
    v_and_b32 v99, v103, v9
    v_mfma_f32_16x16x32_bf16 v[84:87], v[92:95], a[116:119], v[84:87]
    s_waitcnt lgkmcnt(0)
    v_and_b32 v92, v104, v6
    v_and_b32 v93, v104, v7
    v_and_b32 v94, v104, v8
    v_and_b32 v95, v104, v9
    v_mfma_f32_16x16x32_bf16 v[88:91], v[96:99], a[116:119], v[88:91]
    ds_read_b128 v[100:103], v137 offset:256
    v_and_b32 v96, v105, v6
    v_and_b32 v97, v105, v7
    v_and_b32 v98, v105, v8
    v_and_b32 v99, v105, v9
    v_mfma_f32_16x16x32_bf16 v[84:87], v[92:95], a[120:123], v[84:87]
    v_and_b32 v92, v106, v6
    v_and_b32 v93, v106, v7
    v_and_b32 v94, v106, v8
    v_and_b32 v95, v106, v9
    v_mfma_f32_16x16x32_bf16 v[88:91], v[96:99], a[120:123], v[88:91]
    v_and_b32 v96, v107, v6
    v_and_b32 v97, v107, v7
    v_and_b32 v98, v107, v8
    v_and_b32 v99, v107, v9
    v_mfma_f32_16x16x32_bf16 v[84:87], v[92:95], a[124:127], v[84:87]
    s_waitcnt lgkmcnt(0)
    v_and_b32 v92, v100, v6
    v_and_b32 v93, v100, v7
    v_and_b32 v94, v100, v8
    v_and_b32 v95, v100, v9
    v_mfma_f32_16x16x32_bf16 v[88:91], v[96:99], a[124:127], v[88:91]
    s_waitcnt vmcnt(5)
    buffer_load_dwordx4 a[176:179], v2, s[24:27], s51 offen nt
    s_add_u32 s51, s51, 16384
    ds_read_b64_tr_b16 v[208:209], v138 offset:112
    ds_read_b64_tr_b16 v[210:211], v138 offset:3696
    ds_read_b64_tr_b16 v[212:213], v138 offset:28784
    ds_read_b64_tr_b16 v[214:215], v138 offset:32368
    ds_read_b128 v[104:107], v137 offset:272
    v_and_b32 v96, v101, v6
    v_and_b32 v97, v101, v7
    v_and_b32 v98, v101, v8
    v_and_b32 v99, v101, v9
    v_mfma_f32_16x16x32_bf16 v[84:87], v[92:95], a[128:131], v[84:87]
    v_and_b32 v92, v102, v6
    v_and_b32 v93, v102, v7
    v_and_b32 v94, v102, v8
    v_and_b32 v95, v102, v9
    v_mfma_f32_16x16x32_bf16 v[88:91], v[96:99], a[128:131], v[88:91]
    v_and_b32 v96, v103, v6
    v_and_b32 v97, v103, v7
    v_and_b32 v98, v103, v8
    v_and_b32 v99, v103, v9
    v_mfma_f32_16x16x32_bf16 v[84:87], v[92:95], a[132:135], v[84:87]
    s_waitcnt lgkmcnt(0)
    v_and_b32 v92, v104, v6
    v_and_b32 v93, v104, v7
    v_and_b32 v94, v104, v8
    v_and_b32 v95, v104, v9
    v_mfma_f32_16x16x32_bf16 v[88:91], v[96:99], a[132:135], v[88:91]
    ds_read_b128 v[100:103], v137 offset:288
    v_and_b32 v96, v105, v6
    v_and_b32 v97, v105, v7
    v_and_b32 v98, v105, v8
    v_and_b32 v99, v105, v9
    v_mfma_f32_16x16x32_bf16 v[84:87], v[92:95], a[136:139], v[84:87]
    v_and_b32 v92, v106, v6
    v_and_b32 v93, v106, v7
    v_and_b32 v94, v106, v8
    v_and_b32 v95, v106, v9
    v_mfma_f32_16x16x32_bf16 v[88:91], v[96:99], a[136:139], v[88:91]
    v_and_b32 v96, v107, v6
    v_and_b32 v97, v107, v7
    v_and_b32 v98, v107, v8
    v_and_b32 v99, v107, v9
    v_mfma_f32_16x16x32_bf16 v[84:87], v[92:95], a[140:143], v[84:87]
    s_waitcnt lgkmcnt(0)
    v_and_b32 v92, v100, v6
    v_and_b32 v93, v100, v7
    v_and_b32 v94, v100, v8
    v_and_b32 v95, v100, v9
    v_mfma_f32_16x16x32_bf16 v[88:91], v[96:99], a[140:143], v[88:91]
    s_waitcnt vmcnt(5)
    buffer_load_dwordx4 a[180:183], v2, s[24:27], s51 offen nt
    s_sub_u32 s51, s51, 245760
    ds_read_b64_tr_b16 v[216:217], v139 offset:112
    ds_read_b64_tr_b16 v[218:219], v139 offset:3696
    ds_read_b64_tr_b16 v[220:221], v139 offset:28784
    ds_read_b64_tr_b16 v[222:223], v139 offset:32368
    ds_read_b128 v[104:107], v137 offset:304
    v_and_b32 v96, v101, v6
    v_and_b32 v97, v101, v7
    v_and_b32 v98, v101, v8
    v_and_b32 v99, v101, v9
    v_mfma_f32_16x16x32_bf16 v[84:87], v[92:95], a[144:147], v[84:87]
    v_and_b32 v92, v102, v6
    v_and_b32 v93, v102, v7
    v_and_b32 v94, v102, v8
    v_and_b32 v95, v102, v9
    v_mfma_f32_16x16x32_bf16 v[88:91], v[96:99], a[144:147], v[88:91]
    v_and_b32 v96, v103, v6
    v_and_b32 v97, v103, v7
    v_and_b32 v98, v103, v8
    v_and_b32 v99, v103, v9
    v_mfma_f32_16x16x32_bf16 v[84:87], v[92:95], a[148:151], v[84:87]
    s_waitcnt lgkmcnt(0)
    v_and_b32 v92, v104, v6
    v_and_b32 v93, v104, v7
    v_and_b32 v94, v104, v8
    v_and_b32 v95, v104, v9
    v_mfma_f32_16x16x32_bf16 v[88:91], v[96:99], a[148:151], v[88:91]
    ds_read_b128 v[100:103], v137 offset:320
    v_and_b32 v96, v105, v6
    v_and_b32 v97, v105, v7
    v_and_b32 v98, v105, v8
    v_and_b32 v99, v105, v9
    v_mfma_f32_16x16x32_bf16 v[84:87], v[92:95], a[152:155], v[84:87]
    v_and_b32 v92, v106, v6
    v_and_b32 v93, v106, v7
    v_and_b32 v94, v106, v8
    v_and_b32 v95, v106, v9
    v_mfma_f32_16x16x32_bf16 v[88:91], v[96:99], a[152:155], v[88:91]
    v_and_b32 v96, v107, v6
    v_and_b32 v97, v107, v7
    v_and_b32 v98, v107, v8
    v_and_b32 v99, v107, v9
    v_mfma_f32_16x16x32_bf16 v[84:87], v[92:95], a[156:159], v[84:87]
    s_waitcnt lgkmcnt(0)
    v_and_b32 v92, v100, v6
    v_and_b32 v93, v100, v7
    v_and_b32 v94, v100, v8
    v_and_b32 v95, v100, v9
    v_mfma_f32_16x16x32_bf16 v[88:91], v[96:99], a[156:159], v[88:91]
    s_waitcnt vmcnt(5)
    buffer_load_dwordx4 a[184:187], v2, s[24:27], s51 offen nt
    s_add_u32 s51, s51, 16384
    ds_read_b64_tr_b16 v[224:225], v138 offset:136
    ds_read_b64_tr_b16 v[226:227], v138 offset:3720
    ds_read_b64_tr_b16 v[228:229], v138 offset:28808
    ds_read_b64_tr_b16 v[230:231], v138 offset:32392
    ds_read_b128 v[104:107], v137 offset:336
    v_and_b32 v96, v101, v6
    v_and_b32 v97, v101, v7
    v_and_b32 v98, v101, v8
    v_and_b32 v99, v101, v9
    v_mfma_f32_16x16x32_bf16 v[84:87], v[92:95], a[160:163], v[84:87]
    v_and_b32 v92, v102, v6
    v_and_b32 v93, v102, v7
    v_and_b32 v94, v102, v8
    v_and_b32 v95, v102, v9
    v_mfma_f32_16x16x32_bf16 v[88:91], v[96:99], a[160:163], v[88:91]
    s_waitcnt vmcnt(5)
    buffer_load_dwordx4 a[188:191], v2, s[24:27], s51 offen nt
    s_add_u32 s51, s51, 294912
    ds_read_b64_tr_b16 v[232:233], v139 offset:136
    ds_read_b64_tr_b16 v[234:235], v139 offset:3720
    ds_read_b64_tr_b16 v[236:237], v139 offset:28808
    ds_read_b64_tr_b16 v[238:239], v139 offset:32392
    v_and_b32 v96, v103, v6
    v_and_b32 v97, v103, v7
    v_and_b32 v98, v103, v8
    v_and_b32 v99, v103, v9
    v_mfma_f32_16x16x32_bf16 v[84:87], v[92:95], a[164:167], v[84:87]
    s_waitcnt lgkmcnt(0)
    v_and_b32 v92, v104, v6
    v_and_b32 v93, v104, v7
    v_and_b32 v94, v104, v8
    v_and_b32 v95, v104, v9
    v_mfma_f32_16x16x32_bf16 v[88:91], v[96:99], a[164:167], v[88:91]
    s_waitcnt vmcnt(5)
    buffer_load_dwordx4 a[192:195], v2, s[24:27], s51 offen nt
    s_add_u32 s51, s51, 16384
    ds_read_b64_tr_b16 v[240:241], v138 offset:168
    ds_read_b64_tr_b16 v[242:243], v138 offset:3752
    ds_read_b64_tr_b16 v[244:245], v138 offset:28840
    ds_read_b64_tr_b16 v[246:247], v138 offset:32424
    ds_read_b128 v[100:103], v137 offset:352
    v_and_b32 v96, v105, v6
    v_and_b32 v97, v105, v7
    v_and_b32 v98, v105, v8
    v_and_b32 v99, v105, v9
    v_mfma_f32_16x16x32_bf16 v[84:87], v[92:95], a[168:171], v[84:87]
    v_and_b32 v92, v106, v6
    v_and_b32 v93, v106, v7
    v_and_b32 v94, v106, v8
    v_and_b32 v95, v106, v9
    v_mfma_f32_16x16x32_bf16 v[88:91], v[96:99], a[168:171], v[88:91]
    s_waitcnt vmcnt(5)
    buffer_load_dwordx4 a[196:199], v2, s[24:27], s51 offen nt
    s_add_u32 s51, s51, 16384
    ds_read_b64_tr_b16 v[248:249], v139 offset:168
    ds_read_b64_tr_b16 v[250:251], v139 offset:3752
    ds_read_b64_tr_b16 v[252:253], v139 offset:28840
    ds_read_b64_tr_b16 v[254:255], v139 offset:32424
    v_and_b32 v96, v107, v6
    v_and_b32 v97, v107, v7
    v_and_b32 v98, v107, v8
    v_and_b32 v99, v107, v9
    v_mfma_f32_16x16x32_bf16 v[84:87], v[92:95], a[172:175], v[84:87]
    s_waitcnt lgkmcnt(0)
    v_and_b32 v92, v100, v6
    v_and_b32 v93, v100, v7
    v_and_b32 v94, v100, v8
    v_and_b32 v95, v100, v9
    v_mfma_f32_16x16x32_bf16 v[88:91], v[96:99], a[172:175], v[88:91]
    s_waitcnt vmcnt(5)
    buffer_load_dwordx4 a[200:203], v2, s[24:27], s51 offen nt
    s_add_u32 s51, s51, 16384
    ds_read_b64_tr_b16 v[16:17], v138 offset:192
    ds_read_b64_tr_b16 v[18:19], v138 offset:3776
    ds_read_b64_tr_b16 v[20:21], v138 offset:28864
    ds_read_b64_tr_b16 v[22:23], v138 offset:32448
    ds_read_b128 v[104:107], v137 offset:368
    v_and_b32 v96, v101, v6
    v_and_b32 v97, v101, v7
    v_and_b32 v98, v101, v8
    v_and_b32 v99, v101, v9
    v_mfma_f32_16x16x32_bf16 v[84:87], v[92:95], a[176:179], v[84:87]
    v_and_b32 v92, v102, v6
    v_and_b32 v93, v102, v7
    v_and_b32 v94, v102, v8
    v_and_b32 v95, v102, v9
    v_mfma_f32_16x16x32_bf16 v[88:91], v[96:99], a[176:179], v[88:91]
    s_waitcnt vmcnt(5)
    buffer_load_dwordx4 a[204:207], v2, s[24:27], s51 offen nt
    s_add_u32 s51, s51, 16384
    ds_read_b64_tr_b16 v[24:25], v139 offset:192
    ds_read_b64_tr_b16 v[26:27], v139 offset:3776
    ds_read_b64_tr_b16 v[28:29], v139 offset:28864
    ds_read_b64_tr_b16 v[30:31], v139 offset:32448
    v_and_b32 v96, v103, v6
    v_and_b32 v97, v103, v7
    v_and_b32 v98, v103, v8
    v_and_b32 v99, v103, v9
    v_mfma_f32_16x16x32_bf16 v[84:87], v[92:95], a[180:183], v[84:87]
    s_waitcnt lgkmcnt(0)
    v_and_b32 v92, v104, v6
    v_and_b32 v93, v104, v7
    v_and_b32 v94, v104, v8
    v_and_b32 v95, v104, v9
    v_mfma_f32_16x16x32_bf16 v[88:91], v[96:99], a[180:183], v[88:91]
    s_waitcnt vmcnt(5)
    buffer_load_dwordx4 a[208:211], v2, s[24:27], s51 offen nt
    s_add_u32 s51, s51, 16384
    ds_read_b128 v[100:103], v137 offset:384
    v_and_b32 v96, v105, v6
    v_and_b32 v97, v105, v7
    v_and_b32 v98, v105, v8
    v_and_b32 v99, v105, v9
    v_mfma_f32_16x16x32_bf16 v[84:87], v[92:95], a[184:187], v[84:87]
    v_and_b32 v92, v106, v6
    v_and_b32 v93, v106, v7
    v_and_b32 v94, v106, v8
    v_and_b32 v95, v106, v9
    v_mfma_f32_16x16x32_bf16 v[88:91], v[96:99], a[184:187], v[88:91]
    s_waitcnt vmcnt(5)
    buffer_load_dwordx4 a[212:215], v2, s[24:27], s51 offen nt
    s_add_u32 s51, s51, 16384
    v_and_b32 v96, v107, v6
    v_and_b32 v97, v107, v7
    v_and_b32 v98, v107, v8
    v_and_b32 v99, v107, v9
    v_mfma_f32_16x16x32_bf16 v[84:87], v[92:95], a[188:191], v[84:87]
    s_waitcnt lgkmcnt(0)
    v_and_b32 v92, v100, v6
    v_and_b32 v93, v100, v7
    v_and_b32 v94, v100, v8
    v_and_b32 v95, v100, v9
    v_mfma_f32_16x16x32_bf16 v[88:91], v[96:99], a[188:191], v[88:91]
    s_waitcnt vmcnt(5)
    buffer_load_dwordx4 a[216:219], v2, s[24:27], s51 offen nt
    s_add_u32 s51, s51, 16384
    ds_read_b128 v[104:107], v137 offset:400
    v_and_b32 v96, v101, v6
    v_and_b32 v97, v101, v7
    v_and_b32 v98, v101, v8
    v_and_b32 v99, v101, v9
    v_mfma_f32_16x16x32_bf16 v[84:87], v[92:95], a[192:195], v[84:87]
    v_and_b32 v92, v102, v6
    v_and_b32 v93, v102, v7
    v_and_b32 v94, v102, v8
    v_and_b32 v95, v102, v9
    v_mfma_f32_16x16x32_bf16 v[88:91], v[96:99], a[192:195], v[88:91]
    s_waitcnt vmcnt(5)
    buffer_load_dwordx4 a[220:223], v2, s[24:27], s51 offen nt
    s_add_u32 s51, s51, 16384
    v_and_b32 v96, v103, v6
    v_and_b32 v97, v103, v7
    v_and_b32 v98, v103, v8
    v_and_b32 v99, v103, v9
    v_mfma_f32_16x16x32_bf16 v[84:87], v[92:95], a[196:199], v[84:87]
    s_waitcnt lgkmcnt(0)
    v_and_b32 v92, v104, v6
    v_and_b32 v93, v104, v7
    v_and_b32 v94, v104, v8
    v_and_b32 v95, v104, v9
    v_mfma_f32_16x16x32_bf16 v[88:91], v[96:99], a[196:199], v[88:91]
    s_waitcnt vmcnt(5)
    buffer_load_dwordx4 a[224:227], v2, s[24:27], s51 offen nt
    s_add_u32 s51, s51, 16384
    ds_read_b128 v[100:103], v137 offset:416
    v_and_b32 v96, v105, v6
    v_and_b32 v97, v105, v7
    v_and_b32 v98, v105, v8
    v_and_b32 v99, v105, v9
    v_mfma_f32_16x16x32_bf16 v[84:87], v[92:95], a[200:203], v[84:87]
    v_and_b32 v92, v106, v6
    v_and_b32 v93, v106, v7
    v_and_b32 v94, v106, v8
    v_and_b32 v95, v106, v9
    v_mfma_f32_16x16x32_bf16 v[88:91], v[96:99], a[200:203], v[88:91]
    s_waitcnt vmcnt(5)
    buffer_load_dwordx4 a[228:231], v2, s[24:27], s51 offen nt
    s_add_u32 s51, s51, 16384
    v_and_b32 v96, v107, v6
    v_and_b32 v97, v107, v7
    v_and_b32 v98, v107, v8
    v_and_b32 v99, v107, v9
    v_mfma_f32_16x16x32_bf16 v[84:87], v[92:95], a[204:207], v[84:87]
    s_waitcnt lgkmcnt(0)
    v_and_b32 v92, v100, v6
    v_and_b32 v93, v100, v7
    v_and_b32 v94, v100, v8
    v_and_b32 v95, v100, v9
    v_mfma_f32_16x16x32_bf16 v[88:91], v[96:99], a[204:207], v[88:91]
    s_waitcnt vmcnt(5)
    buffer_load_dwordx4 a[232:235], v2, s[24:27], s51 offen nt
    s_add_u32 s51, s51, 16384
    ds_read_b128 v[104:107], v137 offset:432
    v_and_b32 v96, v101, v6
    v_and_b32 v97, v101, v7
    v_and_b32 v98, v101, v8
    v_and_b32 v99, v101, v9
    v_mfma_f32_16x16x32_bf16 v[84:87], v[92:95], a[208:211], v[84:87]
    v_and_b32 v92, v102, v6
    v_and_b32 v93, v102, v7
    v_and_b32 v94, v102, v8
    v_and_b32 v95, v102, v9
    v_mfma_f32_16x16x32_bf16 v[88:91], v[96:99], a[208:211], v[88:91]
    s_waitcnt vmcnt(5)
    buffer_load_dwordx4 a[236:239], v2, s[24:27], s51 offen nt
    s_add_u32 s51, s51, 16384
    v_and_b32 v96, v103, v6
    v_and_b32 v97, v103, v7
    v_and_b32 v98, v103, v8
    v_and_b32 v99, v103, v9
    v_mfma_f32_16x16x32_bf16 v[84:87], v[92:95], a[212:215], v[84:87]
    s_waitcnt lgkmcnt(0)
    v_and_b32 v92, v104, v6
    v_and_b32 v93, v104, v7
    v_and_b32 v94, v104, v8
    v_and_b32 v95, v104, v9
    v_mfma_f32_16x16x32_bf16 v[88:91], v[96:99], a[212:215], v[88:91]
    s_waitcnt vmcnt(5)
    buffer_load_dwordx4 a[240:243], v2, s[24:27], s51 offen nt
    s_sub_u32 s51, s51, 245760
    ds_read_b128 v[100:103], v137 offset:448
    v_and_b32 v96, v105, v6
    v_and_b32 v97, v105, v7
    v_and_b32 v98, v105, v8
    v_and_b32 v99, v105, v9
    v_mfma_f32_16x16x32_bf16 v[84:87], v[92:95], a[216:219], v[84:87]
    v_and_b32 v92, v106, v6
    v_and_b32 v93, v106, v7
    v_and_b32 v94, v106, v8
    v_and_b32 v95, v106, v9
    v_mfma_f32_16x16x32_bf16 v[88:91], v[96:99], a[216:219], v[88:91]
    s_waitcnt vmcnt(5)
    buffer_load_dwordx4 a[244:247], v2, s[24:27], s51 offen nt
    s_add_u32 s51, s51, 16384
    v_and_b32 v96, v107, v6
    v_and_b32 v97, v107, v7
    v_and_b32 v98, v107, v8
    v_and_b32 v99, v107, v9
    v_mfma_f32_16x16x32_bf16 v[84:87], v[92:95], a[220:223], v[84:87]
    s_waitcnt lgkmcnt(0)
    v_and_b32 v92, v100, v6
    v_and_b32 v93, v100, v7
    v_and_b32 v94, v100, v8
    v_and_b32 v95, v100, v9
    v_mfma_f32_16x16x32_bf16 v[88:91], v[96:99], a[220:223], v[88:91]
    s_waitcnt vmcnt(5)
    buffer_load_dwordx4 a[248:251], v2, s[24:27], s51 offen nt
    s_add_u32 s51, s51, 16384
    ds_read_b128 v[104:107], v137 offset:464
    v_and_b32 v96, v101, v6
    v_and_b32 v97, v101, v7
    v_and_b32 v98, v101, v8
    v_and_b32 v99, v101, v9
    v_mfma_f32_16x16x32_bf16 v[84:87], v[92:95], a[224:227], v[84:87]
    v_and_b32 v92, v102, v6
    v_and_b32 v93, v102, v7
    v_and_b32 v94, v102, v8
    v_and_b32 v95, v102, v9
    v_mfma_f32_16x16x32_bf16 v[88:91], v[96:99], a[224:227], v[88:91]
    s_waitcnt vmcnt(5)
    buffer_load_dwordx4 a[252:255], v2, s[24:27], s51 offen nt
    v_and_b32 v96, v103, v6
    v_and_b32 v97, v103, v7
    v_and_b32 v98, v103, v8
    v_and_b32 v99, v103, v9
    v_mfma_f32_16x16x32_bf16 v[84:87], v[92:95], a[228:231], v[84:87]
    s_waitcnt lgkmcnt(0)
    v_and_b32 v92, v104, v6
    v_and_b32 v93, v104, v7
    v_and_b32 v94, v104, v8
    v_and_b32 v95, v104, v9
    v_mfma_f32_16x16x32_bf16 v[88:91], v[96:99], a[228:231], v[88:91]
    ds_read_b128 v[100:103], v137 offset:480
    v_and_b32 v96, v105, v6
    v_and_b32 v97, v105, v7
    v_and_b32 v98, v105, v8
    v_and_b32 v99, v105, v9
    s_waitcnt vmcnt(5)
    v_mfma_f32_16x16x32_bf16 v[84:87], v[92:95], a[232:235], v[84:87]
    v_and_b32 v92, v106, v6
    v_and_b32 v93, v106, v7
    v_and_b32 v94, v106, v8
    v_and_b32 v95, v106, v9
    v_mfma_f32_16x16x32_bf16 v[88:91], v[96:99], a[232:235], v[88:91]
    v_and_b32 v96, v107, v6
    v_and_b32 v97, v107, v7
    v_and_b32 v98, v107, v8
    v_and_b32 v99, v107, v9
    s_waitcnt vmcnt(4)
    v_mfma_f32_16x16x32_bf16 v[84:87], v[92:95], a[236:239], v[84:87]
    s_waitcnt lgkmcnt(0)
    v_and_b32 v92, v100, v6
    v_and_b32 v93, v100, v7
    v_and_b32 v94, v100, v8
    v_and_b32 v95, v100, v9
    v_mfma_f32_16x16x32_bf16 v[88:91], v[96:99], a[236:239], v[88:91]
    ds_read_b128 v[104:107], v137 offset:496
    v_and_b32 v96, v101, v6
    v_and_b32 v97, v101, v7
    v_and_b32 v98, v101, v8
    v_and_b32 v99, v101, v9
    s_waitcnt vmcnt(3)
    v_mfma_f32_16x16x32_bf16 v[84:87], v[92:95], a[240:243], v[84:87]
    v_and_b32 v92, v102, v6
    v_and_b32 v93, v102, v7
    v_and_b32 v94, v102, v8
    v_and_b32 v95, v102, v9
    v_mfma_f32_16x16x32_bf16 v[88:91], v[96:99], a[240:243], v[88:91]
    v_and_b32 v96, v103, v6
    v_and_b32 v97, v103, v7
    v_and_b32 v98, v103, v8
    v_and_b32 v99, v103, v9
    s_waitcnt vmcnt(2)
    v_mfma_f32_16x16x32_bf16 v[84:87], v[92:95], a[244:247], v[84:87]
    s_waitcnt lgkmcnt(0)
    v_and_b32 v92, v104, v6
    v_and_b32 v93, v104, v7
    v_and_b32 v94, v104, v8
    v_and_b32 v95, v104, v9
    v_mfma_f32_16x16x32_bf16 v[88:91], v[96:99], a[244:247], v[88:91]
    v_and_b32 v96, v105, v6
    v_and_b32 v97, v105, v7
    v_and_b32 v98, v105, v8
    v_and_b32 v99, v105, v9
    s_waitcnt vmcnt(1)
    v_mfma_f32_16x16x32_bf16 v[84:87], v[92:95], a[248:251], v[84:87]
    v_and_b32 v92, v106, v6
    v_and_b32 v93, v106, v7
    v_and_b32 v94, v106, v8
    v_and_b32 v95, v106, v9
    v_mfma_f32_16x16x32_bf16 v[88:91], v[96:99], a[248:251], v[88:91]
    v_and_b32 v96, v107, v6
    v_and_b32 v97, v107, v7
    v_and_b32 v98, v107, v8
    v_and_b32 v99, v107, v9
    s_waitcnt vmcnt(0)
    v_mfma_f32_16x16x32_bf16 v[84:87], v[92:95], a[252:255], v[84:87]
    s_nop 0
    v_mfma_f32_16x16x32_bf16 v[88:91], v[96:99], a[252:255], v[88:91]
    s_nop 7
    v_add_f32_dpp v64, v88, v84 row_ror:8 row_mask:0xf bank_mask:0xf
    v_add_f32_dpp v65, v89, v85 row_ror:8 row_mask:0xf bank_mask:0xf
    v_add_f32_dpp v66, v90, v86 row_ror:8 row_mask:0xf bank_mask:0xf
    v_add_f32_dpp v67, v91, v87 row_ror:8 row_mask:0xf bank_mask:0xf
    v_cvt_pk_bf16_f32 v68, v64, v65
    v_cvt_pk_bf16_f32 v69, v66, v67
    ds_write2_b32 v140, v68, v69 offset1:144
    s_waitcnt lgkmcnt(0)
    s_barrier
    ds_read_b128 v[32:35], v141 offset:0
    ds_read_b128 v[36:39], v141 offset:272
    s_mov_b64 vcc, s[4:5]
    s_waitcnt lgkmcnt(1)
    v_smfmac_f32_16x16x64_bf16 v[112:115], v[32:35], v[160:167], v14
    v_smfmac_f32_16x16x64_bf16 v[120:123], v[32:35], v[192:199], v14
    s_waitcnt lgkmcnt(0)
    v_smfmac_f32_16x16x64_bf16 v[112:115], v[36:39], v[168:175], v14
    v_smfmac_f32_16x16x64_bf16 v[120:123], v[36:39], v[200:207], v14
    v_smfmac_f32_16x16x64_bf16 v[128:131], v[32:35], v[224:231], v14
    v_smfmac_f32_16x16x64_bf16 v[128:131], v[36:39], v[232:239], v14
    v_smfmac_f32_16x16x64_bf16 v[40:43], v[32:35], v[16:23], v14
    v_smfmac_f32_16x16x64_bf16 v[40:43], v[36:39], v[24:31], v14
    v_smfmac_f32_16x16x64_bf16 v[108:111], v[32:35], v[144:151], v14
    v_smfmac_f32_16x16x64_bf16 v[108:111], v[36:39], v[152:159], v14
    v_smfmac_f32_16x16x64_bf16 v[116:119], v[32:35], v[176:183], v14
    v_add_f32_dpp v73, v112, v113 quad_perm:[0,1,2,3] row_mask:0x5 bank_mask:0xf
    v_add_f32_dpp v77, v114, v115 quad_perm:[0,1,2,3] row_mask:0x5 bank_mask:0xf
    v_add_f32_dpp v73, v120, v121 quad_perm:[0,1,2,3] row_mask:0xa bank_mask:0xf
    v_add_f32_dpp v77, v122, v123 quad_perm:[0,1,2,3] row_mask:0xa bank_mask:0xf
    v_smfmac_f32_16x16x64_bf16 v[116:119], v[36:39], v[184:191], v14
    v_add_f32_dpp v75, v128, v129 quad_perm:[0,1,2,3] row_mask:0x5 bank_mask:0xf
    v_add_f32_dpp v79, v130, v131 quad_perm:[0,1,2,3] row_mask:0x5 bank_mask:0xf
    v_add_f32 v73, v73, v77
    v_smfmac_f32_16x16x64_bf16 v[124:127], v[32:35], v[208:215], v14
    v_add_f32_dpp v75, v40, v41 quad_perm:[0,1,2,3] row_mask:0xa bank_mask:0xf
    v_add_f32_dpp v79, v42, v43 quad_perm:[0,1,2,3] row_mask:0xa bank_mask:0xf
    v_add_f32 v75, v75, v79
    v_smfmac_f32_16x16x64_bf16 v[124:127], v[36:39], v[216:223], v14
    v_add_f32_dpp v72, v108, v109 quad_perm:[0,1,2,3] row_mask:0x5 bank_mask:0xf
    v_add_f32_dpp v76, v110, v111 quad_perm:[0,1,2,3] row_mask:0x5 bank_mask:0xf
    v_add_f32_dpp v72, v116, v117 quad_perm:[0,1,2,3] row_mask:0xa bank_mask:0xf
    v_add_f32_dpp v76, v118, v119 quad_perm:[0,1,2,3] row_mask:0xa bank_mask:0xf
    v_permlane32_swap_b32 v73, v75
    v_smfmac_f32_16x16x64_bf16 v[132:135], v[32:35], v[240:247], v14
    v_add_f32 v73, v73, v75
    v_add_f32 v72, v72, v76
    v_smfmac_f32_16x16x64_bf16 v[132:135], v[36:39], v[248:255], v14
    v_cndmask_b32_dpp v73, v73, v12, vcc row_ror:15 row_mask:0xf bank_mask:0xf
    v_cvt_f64_f32 v[82:83], v73
    buffer_atomic_add_f64 v[82:83], v46, s[28:31], s65 offen offset:1024 sc0 sc1
    v_add_f32_dpp v74, v124, v125 quad_perm:[0,1,2,3] row_mask:0x5 bank_mask:0xf
    v_add_f32_dpp v78, v126, v127 quad_perm:[0,1,2,3] row_mask:0x5 bank_mask:0xf
    s_mul_i32 s59, s48, 224
    s_mul_i32 s60, s54, 896
    s_add_u32 s59, s59, s60
    v_add_f32_dpp v74, v132, v133 quad_perm:[0,1,2,3] row_mask:0xa bank_mask:0xf
    v_add_f32_dpp v78, v134, v135 quad_perm:[0,1,2,3] row_mask:0xa bank_mask:0xf
    v_add_f32 v74, v74, v78
    s_cmp_lg_u32 s65, 1572864
    s_nop 0
    v_permlane32_swap_b32 v72, v74
    s_nop 0
    v_add_f32 v72, v72, v74
    s_nop 1
    v_cndmask_b32_dpp v72, v72, v12, vcc row_ror:1 row_mask:0xf bank_mask:0xf
    v_cvt_f64_f32 v[80:81], v72
    buffer_atomic_add_f64 v[80:81], v46, s[28:31], s65 offen sc0 sc1
    v_cvt_f64_f32 v[66:67], v73
    v_cvt_f64_f32 v[64:65], v72
    s_waitcnt vmcnt(1)
    v_add_f64 v[66:67], v[82:83], v[66:67]
    v_xor_b32_dpp v5, v83, v47 row_newbcast:0 row_mask:0xf bank_mask:0x3
    v_xor_b32_dpp v5, v83, v47 row_newbcast:15 row_mask:0xf bank_mask:0xc
    v_cvt_f32_f64 v82, v[66:67]
    v_or_b32 v45, v5, v44
    v_cvt_pk_bf16_f32 v82, v82, v82
    buffer_store_short v82, v45, s[44:47], s59 offen offset:28
    s_waitcnt vmcnt(1)
    v_add_f64 v[64:65], v[80:81], v[64:65]
    v_xor_b32_dpp v5, v81, v47 row_newbcast:0 row_mask:0xf bank_mask:0x3
    v_xor_b32_dpp v5, v81, v47 row_newbcast:15 row_mask:0xf bank_mask:0xc
    v_cvt_f32_f64 v80, v[64:65]
    v_or_b32 v44, v5, v44
    v_cvt_pk_bf16_f32 v80, v80, v80
    buffer_store_short v80, v44, s[44:47], s59 offen offset:0
    s_cbranch_scc1 L_noep
    v_cmp_eq_u32 vcc, 0, v5
    s_and_b64 exec, vcc, 2
    buffer_store_dword v13, off, s[28:31], 0 sc1
L_noep:
L_end:
    s_endpgm
.section .rodata,"a"
.p2align 6
.amdhsa_kernel standalone__sliding_block_cached__decode_kernel
  .amdhsa_next_free_vgpr 512
  .amdhsa_next_free_sgpr 102
  .amdhsa_accum_offset 256
  .amdhsa_group_segment_fixed_size 0
  .amdhsa_kernarg_size 64
  .amdhsa_user_sgpr_count 2
  .amdhsa_user_sgpr_kernarg_segment_ptr 1
  .amdhsa_system_sgpr_workgroup_id_x 1
.end_amdhsa_kernel
```
